```python
import torch

def _softmax(x, axis=-1):
    return torch.softmax(x, dim=axis)
def _gelu(x):
    return torch.nn.functional.gelu(x, approximate="tanh")
def _silu(x):
    return torch.nn.functional.silu(x)
def _sigmoid(x):
    return torch.sigmoid(x)
def _layernorm(x, axis=-1, eps=1e-5):
    m = x.mean(dim=axis, keepdim=True)
    v = x.var(dim=axis, keepdim=True, unbiased=False)
    return (x - m) / torch.sqrt(v + eps)
def _scatter_add(tgt, idx, src, axis=0):
    return tgt.clone().index_add_(axis, idx, src)
def _segment_sum(src, seg, n):
    out = torch.zeros((n,) + src.shape[1:], dtype=src.dtype)
    return out.index_add_(0, seg, src)
def _pad(x, pw):
    flat = tuple(v for pair in reversed(pw) for v in pair)
    return torch.nn.functional.pad(x, flat)

kernel_name = 'standalone__edge_featured_mpnn_mpnn__graph'

def setup_inputs():

    _w = (lambda a: (lambda t: t.to(torch.bfloat16) if t.is_floating_point() else t)(torch.as_tensor(a)))
    N, deg, D, De = 10000, 64, 64, max(4, 1)
    E = N * deg
    H = 2 * D
    return {
        "x": _w((lambda *s: torch.randn(*s, dtype=torch.bfloat16) * 0.05)(N, D)),
        "e_attr": _w((lambda *s: torch.randn(*s, dtype=torch.bfloat16) * 1.6)(E, De)),
        "src": _w((lambda lo, hi, *s: torch.randint(lo, hi, s))(0, N, E).to(torch.int64)),
        "dst": _w((lambda lo, hi, *s: torch.randint(lo, hi, s))(0, N, E).to(torch.int64)),
        "w1": _w((lambda *s: torch.randn(*s, dtype=torch.bfloat16) * 1.6)(2 * D + De, H) * (1.0 / (2 * D + De) ** 0.5)),
        "b1": _w((lambda *s: torch.randn(*s, dtype=torch.bfloat16) * 3.2)(H) * 0.01),
        "w2": _w((lambda *s: torch.randn(*s, dtype=torch.bfloat16) * 0.05)(H, D) * (1.0 / H ** 0.5)),
        "b2": _w((lambda *s: torch.randn(*s, dtype=torch.bfloat16) * 0.05)(D) * 0.01),
    }

def reference(x, e_attr, src, dst, w1, b1, w2, b2):
    N, D = x.shape
    h_src = x[src]
    h_dst = x[dst]
    m_in = torch.concatenate([h_src, h_dst, e_attr], axis=-1)
    h = _silu(m_in @ w1 + b1)
    msg = h @ w2 + b2
    return _segment_sum(msg, dst, N)
```

```asm
; @launch grid=(256,1,1) block=(512,1,1) lds=163840
.amdgcn_target "amdgcn-amd-amdhsa--gfx950"
.text
.globl standalone__edge_featured_mpnn_mpnn__graph_kernel
.p2align 8
.type standalone__edge_featured_mpnn_mpnn__graph_kernel,@function
standalone__edge_featured_mpnn_mpnn__graph_kernel:
    s_cmp_ge_u32 s2, 256
    s_cbranch_scc1 K2_EXIT
    s_load_dwordx4 s[12:15], s[0:1], 8
    s_load_dwordx2 s[16:17], s[0:1], 24
    s_load_dwordx2 s[8:9], s[0:1], 80
    s_load_dwordx2 s[4:5], s[0:1], 0
    s_load_dwordx2 s[6:7], s[0:1], 64
    s_load_dwordx8 s[64:71], s[0:1], 32
    s_cmp_ge_u32 s2, 250
    s_cbranch_scc1 K1_PREP
    v_lshlrev_b32 v1, 4, v0
    v_lshlrev_b32 v2, 5, v0
    v_lshlrev_b32 v3, 2, v0
    v_lshlrev_b32 v49, 3, v0
    s_mul_i32 s36, s2, 10240
    s_mul_i32 s37, s2, 20480
    s_add_u32 s38, s36, 8192
    s_add_u32 s39, s37, 16384
    v_mov_b32 v28, 0
    v_mov_b32 v29, 1
    v_cmp_gt_u32 vcc, 256, v0
    s_and_saveexec_b64 s[40:41], vcc
    ds_write_b32 v3, v28
    s_mov_b64 exec, s[40:41]
    s_waitcnt lgkmcnt(0)
    s_mov_b32 s63, 9371648
    s_load_dword s94, s[8:9], s63
    s_mov_b32 s20, s16
    s_and_b32 s21, s17, 0xffff
    s_mov_b32 s22, 0x271000
    s_mov_b32 s23, 0x00020000
    s_mov_b32 s24, s14
    s_and_b32 s25, s15, 0xffff
    s_mov_b32 s26, 0x271000
    s_mov_b32 s27, 0x00020000
    s_mov_b32 s28, s12
    s_and_b32 s29, s13, 0xffff
    s_mov_b32 s30, 0x4e2000
    s_mov_b32 s31, 0x00020000
    s_mov_b32 s32, s8
    s_and_b32 s33, s9, 0xffff
    s_mov_b32 s34, 0xc00000
    s_mov_b32 s35, 0x00020000
    buffer_load_dwordx4 v[4:7], v1, s[20:23], s36 offen
    buffer_load_dword v50, v3, s[20:23], s38 offen
    s_barrier
    buffer_load_dwordx4 v[8:11], v1, s[24:27], s36 offen
    buffer_load_dword v51, v3, s[24:27], s38 offen
    buffer_load_dwordx4 v[12:15], v2, s[28:31], s37 offen
    buffer_load_dwordx4 v[16:19], v2, s[28:31], s37 offen offset:16
    buffer_load_dwordx2 v[52:53], v49, s[28:31], s39 offen
    s_mov_b32 s40, 26844
    s_waitcnt vmcnt(5)
    v_mul_u32_u24 v20, s40, v4
    v_mul_u32_u24 v21, s40, v5
    v_mul_u32_u24 v22, s40, v6
    v_mul_u32_u24 v23, s40, v7
    v_mul_u32_u24 v54, s40, v50
    v_lshrrev_b32 v20, 18, v20
    v_lshrrev_b32 v21, 18, v21
    v_lshrrev_b32 v22, 18, v22
    v_lshrrev_b32 v23, 18, v23
    v_lshrrev_b32 v54, 18, v54
    v_and_b32 v20, 0x3fc, v20
    v_and_b32 v21, 0x3fc, v21
    v_and_b32 v22, 0x3fc, v22
    v_and_b32 v23, 0x3fc, v23
    v_and_b32 v54, 0x3fc, v54
    ds_add_rtn_u32 v24, v20, v29
    ds_add_rtn_u32 v25, v21, v29
    ds_add_rtn_u32 v26, v22, v29
    ds_add_rtn_u32 v27, v23, v29
    ds_add_rtn_u32 v55, v54, v29
    s_waitcnt lgkmcnt(0)
    s_barrier
    v_cmp_gt_u32 vcc, 64, v0
    s_cbranch_vccz K1_NOSCAN
    ds_read_b128 v[32:35], v1
    s_waitcnt lgkmcnt(0)
    v_add_u32 v36, v32, v33
    v_add_u32 v37, v36, v34
    v_add_u32 v38, v37, v35
    v_mov_b32 v39, v38
    s_nop 1
    v_add_u32_dpp v39, v39, v39 row_shr:1 row_mask:0xf bank_mask:0xf bound_ctrl:0
    s_nop 1
    v_add_u32_dpp v39, v39, v39 row_shr:2 row_mask:0xf bank_mask:0xf bound_ctrl:0
    s_nop 1
    v_add_u32_dpp v39, v39, v39 row_shr:4 row_mask:0xf bank_mask:0xf bound_ctrl:0
    s_nop 1
    v_add_u32_dpp v39, v39, v39 row_shr:8 row_mask:0xf bank_mask:0xf bound_ctrl:0
    s_nop 1
    v_add_u32_dpp v39, v39, v39 row_bcast:15 row_mask:0xa bank_mask:0xf
    s_nop 1
    v_add_u32_dpp v39, v39, v39 row_bcast:31 row_mask:0xc bank_mask:0xf
    s_nop 1
    v_sub_u32 v40, v39, v38
    v_add_u32 v41, v40, v32
    v_add_u32 v42, v40, v36
    v_add_u32 v43, v40, v37
    v_mul_u32_u24 v40, 12, v40
    v_mul_u32_u24 v41, 12, v41
    v_mul_u32_u24 v42, 12, v42
    v_mul_u32_u24 v43, 12, v43
    ds_write_b128 v1, v[40:43] offset:1024
    v_lshl_or_b32 v44, v32, 16, v40
    v_lshl_or_b32 v45, v33, 16, v41
    v_lshl_or_b32 v46, v34, 16, v42
    v_lshl_or_b32 v47, v35, 16, v43
    s_waitcnt lgkmcnt(0)
K1_NOSCAN:
    s_barrier
    ds_read_b32 v32, v20 offset:1024
    ds_read_b32 v33, v21 offset:1024
    ds_read_b32 v34, v22 offset:1024
    ds_read_b32 v35, v23 offset:1024
    ds_read_b32 v56, v54 offset:1024
    s_movk_i32 s42, 2048
    s_waitcnt vmcnt(0)
    v_lshl_or_b32 v36, v4, 18, v8
    v_lshl_or_b32 v37, v5, 18, v9
    v_lshl_or_b32 v38, v6, 18, v10
    v_lshl_or_b32 v39, v7, 18, v11
    v_lshl_or_b32 v57, v50, 18, v51
    s_waitcnt lgkmcnt(0)
    v_mad_u32_u24 v32, v24, 12, v32
    v_mad_u32_u24 v33, v25, 12, v33
    v_mad_u32_u24 v34, v26, 12, v34
    v_mad_u32_u24 v35, v27, 12, v35
    v_mad_u32_u24 v56, v55, 12, v56
    v_add_u32 v32, s42, v32
    v_add_u32 v33, s42, v33
    v_add_u32 v34, s42, v34
    v_add_u32 v35, s42, v35
    v_add_u32 v56, s42, v56
    ds_write2_b32 v32, v12, v13 offset0:0 offset1:1
    ds_write_b32 v32, v36 offset:8
    ds_write2_b32 v33, v14, v15 offset0:0 offset1:1
    ds_write_b32 v33, v37 offset:8
    ds_write2_b32 v34, v16, v17 offset0:0 offset1:1
    ds_write_b32 v34, v38 offset:8
    ds_write2_b32 v35, v18, v19 offset0:0 offset1:1
    ds_write_b32 v35, v39 offset:8
    ds_write2_b32 v56, v52, v53 offset0:0 offset1:1
    ds_write_b32 v56, v57 offset:8
    s_waitcnt lgkmcnt(0)
    s_barrier
    s_and_b32 s50, s2, 7
    s_lshr_b32 s51, s2, 3
    s_lshl_b32 s50, s50, 5
    s_or_b32 s50, s50, s51
    s_lshr_b32 s51, s50, 2
    s_lshl_b32 s51, s51, 13
    s_and_b32 s50, s50, 3
    s_lshl_b32 s50, s50, 3
    s_add_u32 s50, s50, s51
    s_add_u32 s50, s50, 8396612
    v_and_b32 v59, 63, v0
    v_lshlrev_b32 v59, 5, v59
    s_mov_b64 exec, 0x3f
    buffer_load_dword v61, v59, s[32:35], s50 offen sc1
    s_mov_b64 exec, -1
    ds_read_b128 v[4:7], v1 offset:2048
    ds_read_b128 v[8:11], v1 offset:10240
    ds_read_b128 v[12:15], v1 offset:18432
    ds_read_b128 v[16:19], v1 offset:26624
    s_mul_i32 s43, s2, 30720
    s_waitcnt lgkmcnt(3)
    buffer_store_dwordx4 v[4:7], v1, s[32:35], s43 offen sc1
    s_add_u32 s43, s43, 8192
    s_waitcnt lgkmcnt(2)
    buffer_store_dwordx4 v[8:11], v1, s[32:35], s43 offen sc1
    s_add_u32 s43, s43, 8192
    s_waitcnt lgkmcnt(1)
    buffer_store_dwordx4 v[12:15], v1, s[32:35], s43 offen sc1
    s_add_u32 s43, s43, 8192
    s_waitcnt lgkmcnt(0)
    v_cmp_gt_u32 vcc, 384, v0
    s_and_saveexec_b64 s[40:41], vcc
    buffer_store_dwordx4 v[16:19], v1, s[32:35], s43 offen sc1
    s_mov_b64 exec, s[40:41]
    s_branch K1_END
K1_PREP:
    s_waitcnt lgkmcnt(0)
    s_mov_b32 s63, 9371648
    s_load_dword s94, s[8:9], s63
    v_lshrrev_b32 v1, 6, v0
    v_and_b32 v2, 63, v0
    v_readfirstlane_b32 s36, v1
    s_sub_u32 s37, s2, 250
    s_lshl_b32 s37, s37, 3
    s_add_u32 s36, s36, s37
    v_and_b32 v3, 31, v2
    v_lshrrev_b32 v4, 5, v2
    v_lshlrev_b32 v3, 1, v3
    v_lshlrev_b32 v5, 4, v2
    s_mov_b32 s32, s8
    s_and_b32 s33, s9, 0xffff
    s_mov_b32 s34, 0xc00000
    s_mov_b32 s35, 0x00020000
    v_mov_b32 v44, 0
    v_mov_b32 v45, 0
    v_mov_b32 v46, 0
    v_mov_b32 v47, 0
    v_mov_b32 v61, 0
K1_TASK:
    s_cmp_gt_u32 s36, 44
    s_cbranch_scc1 K1_END
    s_cmp_eq_u32 s36, 44
    s_cbranch_scc1 K1_BIAS
    s_mov_b32 s20, s64
    s_and_b32 s21, s65, 0xffff
    s_mov_b32 s22, 0x8400
    s_mov_b32 s23, 0x00020000
    s_movk_i32 s45, 256
    s_movk_i32 s46, 2048
    s_mov_b32 s47, 0xbfb8aa3b
    s_mov_b32 s49, 0
    s_cmp_ge_u32 s36, 36
    s_cbranch_scc1 K1_T_W2
    s_cmp_ge_u32 s36, 20
    s_cbranch_scc1 K1_T_W1B
    s_cmp_ge_u32 s36, 16
    s_cbranch_scc1 K1_T_WQ
    s_lshr_b32 s50, s36, 2
    s_and_b32 s51, s36, 3
    s_lshl_b32 s50, s50, 12
    s_lshl_b32 s51, s51, 6
    s_add_u32 s44, s50, s51
    s_lshl_b32 s48, s36, 10
    s_add_u32 s48, s48, 9437184
    s_branch K1_T_GO
K1_T_WQ:
    s_sub_u32 s51, s36, 16
    s_lshl_b32 s48, s51, 10
    s_add_u32 s48, s48, 9453568
    s_lshl_b32 s51, s51, 6
    s_add_u32 s44, s51, 32768
    s_mov_b32 s46, 0
    s_mov_b32 s49, 1
    s_branch K1_T_GO
K1_T_W1B:
    s_sub_u32 s52, s36, 20
    s_lshr_b32 s50, s52, 2
    s_and_b32 s51, s52, 3
    s_lshl_b32 s50, s50, 12
    s_lshl_b32 s51, s51, 6
    s_add_u32 s44, s50, s51
    s_add_u32 s44, s44, 16384
    s_lshl_b32 s48, s52, 10
    s_add_u32 s48, s48, 9457664
    s_mov_b32 s47, 1.0
    s_branch K1_T_GO
K1_T_W2:
    s_mov_b32 s20, s68
    s_and_b32 s21, s69, 0xffff
    s_mov_b32 s22, 0x4000
    s_mov_b32 s23, 0x00020000
    s_sub_u32 s52, s36, 36
    s_lshl_b32 s44, s52, 11
    s_movk_i32 s45, 128
    s_movk_i32 s46, 1024
    s_mov_b32 s47, 1.0
    s_lshl_b32 s48, s52, 10
    s_add_u32 s48, s48, 9474048
    s_mov_b32 s49, 2
K1_T_GO:
    v_mul_u32_u24 v6, s46, v4
    v_add_u32 v6, v6, v3
    v_add_u32 v6, s44, v6
    v_mov_b32 v7, v6
    buffer_load_ushort v8, v6, s[20:23], 0 offen
    v_add_u32 v6, s45, v6
    buffer_load_ushort v9, v6, s[20:23], 0 offen
    v_add_u32 v6, s45, v6
    buffer_load_ushort v10, v6, s[20:23], 0 offen
    v_add_u32 v6, s45, v6
    buffer_load_ushort v11, v6, s[20:23], 0 offen
    v_add_u32 v6, s45, v6
    buffer_load_ushort v12, v6, s[20:23], 0 offen
    v_add_u32 v6, s45, v6
    buffer_load_ushort v13, v6, s[20:23], 0 offen
    v_add_u32 v6, s45, v6
    buffer_load_ushort v14, v6, s[20:23], 0 offen
    v_add_u32 v6, s45, v6
    buffer_load_ushort v15, v6, s[20:23], 0 offen
    s_cmp_eq_u32 s49, 2
    s_cbranch_scc0 K1_T_ONE
    buffer_load_ushort v32, v7, s[20:23], 0 offen offset:64
    v_add_u32 v7, s45, v7
    buffer_load_ushort v33, v7, s[20:23], 0 offen offset:64
    v_add_u32 v7, s45, v7
    buffer_load_ushort v34, v7, s[20:23], 0 offen offset:64
    v_add_u32 v7, s45, v7
    buffer_load_ushort v35, v7, s[20:23], 0 offen offset:64
    v_add_u32 v7, s45, v7
    buffer_load_ushort v36, v7, s[20:23], 0 offen offset:64
    v_add_u32 v7, s45, v7
    buffer_load_ushort v37, v7, s[20:23], 0 offen offset:64
    v_add_u32 v7, s45, v7
    buffer_load_ushort v38, v7, s[20:23], 0 offen offset:64
    v_add_u32 v7, s45, v7
    buffer_load_ushort v39, v7, s[20:23], 0 offen offset:64
    s_waitcnt vmcnt(0)
    v_lshl_or_b32 v40, v33, 16, v32
    v_lshl_or_b32 v41, v35, 16, v34
    v_lshl_or_b32 v42, v37, 16, v36
    v_lshl_or_b32 v43, v39, 16, v38
    s_add_u32 s50, s48, 8192
    buffer_store_dwordx4 v[40:43], v5, s[32:35], s50 offen sc1
    s_branch K1_T_TWO
K1_T_ONE:
    s_waitcnt vmcnt(0)
K1_T_TWO:
    v_lshlrev_b32 v8, 16, v8
    v_lshlrev_b32 v9, 16, v9
    v_lshlrev_b32 v10, 16, v10
    v_lshlrev_b32 v11, 16, v11
    v_lshlrev_b32 v12, 16, v12
    v_lshlrev_b32 v13, 16, v13
    v_lshlrev_b32 v14, 16, v14
    v_lshlrev_b32 v15, 16, v15
    v_mul_f32 v8, s47, v8
    v_mul_f32 v9, s47, v9
    v_mul_f32 v10, s47, v10
    v_mul_f32 v11, s47, v11
    v_mul_f32 v12, s47, v12
    v_mul_f32 v13, s47, v13
    v_mul_f32 v14, s47, v14
    v_mul_f32 v15, s47, v15
    v_cvt_pk_bf16_f32 v16, v8, v9
    v_cvt_pk_bf16_f32 v17, v10, v11
    v_cvt_pk_bf16_f32 v18, v12, v13
    v_cvt_pk_bf16_f32 v19, v14, v15
    s_cmp_eq_u32 s49, 1
    s_cbranch_scc0 K1_T_NOWQ
    v_lshlrev_b32 v20, 16, v16
    v_and_b32 v21, 0xffff0000, v16
    v_lshlrev_b32 v22, 16, v17
    v_and_b32 v23, 0xffff0000, v17
    v_lshlrev_b32 v24, 16, v18
    v_and_b32 v25, 0xffff0000, v18
    v_lshlrev_b32 v26, 16, v19
    v_and_b32 v27, 0xffff0000, v19
    v_sub_f32 v8, v8, v20
    v_sub_f32 v9, v9, v21
    v_sub_f32 v10, v10, v22
    v_sub_f32 v11, v11, v23
    v_sub_f32 v12, v12, v24
    v_sub_f32 v13, v13, v25
    v_sub_f32 v14, v14, v26
    v_sub_f32 v15, v15, v27
    v_cvt_pk_bf16_f32 v28, v8, v9
    v_cvt_pk_bf16_f32 v29, v10, v11
    v_cvt_pk_bf16_f32 v30, v12, v13
    v_cvt_pk_bf16_f32 v31, v14, v15
    v_cmp_eq_u32 vcc, 1, v4
    s_nop 1
    v_cndmask_b32 v16, v16, v28, vcc
    v_cndmask_b32 v17, v17, v29, vcc
    v_cndmask_b32 v18, v18, v30, vcc
    v_cndmask_b32 v19, v19, v31, vcc
K1_T_NOWQ:
    buffer_store_dwordx4 v[16:19], v5, s[32:35], s48 offen sc1
    s_branch K1_END
K1_BIAS:
    s_mov_b32 s20, s66
    s_and_b32 s21, s67, 0xffff
    s_mov_b32 s22, 0x100
    s_mov_b32 s23, 0x00020000
    s_mov_b32 s24, s70
    s_and_b32 s25, s71, 0xffff
    s_mov_b32 s26, 0x80
    s_mov_b32 s27, 0x00020000
    v_lshlrev_b32 v6, 1, v2
    v_lshlrev_b32 v7, 2, v2
    buffer_load_ushort v8, v6, s[20:23], 0 offen
    buffer_load_ushort v9, v6, s[20:23], 0 offen offset:128
    buffer_load_ushort v10, v6, s[24:27], 0 offen
    s_mov_b32 s47, 0xbfb8aa3b
    s_mov_b32 s48, 9506816
    s_waitcnt vmcnt(0)
    v_lshlrev_b32 v8, 16, v8
    v_lshlrev_b32 v9, 16, v9
    v_lshlrev_b32 v10, 16, v10
    v_mul_f32 v8, s47, v8
    v_mul_f32 v9, s47, v9
    buffer_store_dword v8, v7, s[32:35], s48 offen sc1
    buffer_store_dword v9, v7, s[32:35], s48 offen offset:256 sc1
    buffer_store_dword v10, v7, s[32:35], s48 offen offset:512 sc1
K1_END:
    s_waitcnt lgkmcnt(0)
    s_add_u32 s94, s94, 1
    s_mov_b32 s26, s2
    s_and_b32 s3, s2, 7
    s_lshr_b32 s2, s2, 3
    s_lshl_b32 s3, s3, 5
    s_or_b32 s2, s2, s3
    v_and_b32 v1, 63, v0
    v_lshrrev_b32 v4, 6, v0
    v_lshrrev_b32 v2, 5, v1
    v_readfirstlane_b32 s36, v4
    v_and_b32 v3, 31, v1
    s_mul_i32 s37, s2, 639989
    s_add_u32 s38, s37, 656372
    s_add_u32 s37, s37, 16383
    s_lshr_b32 s37, s37, 14
    s_lshr_b32 s38, s38, 14
    s_sub_u32 s38, s38, s37
    s_mov_b32 s39, 0
    s_lshl_b32 s100, s36, 13
    s_add_u32 s100, s100, 50688
    s_lshl_b32 s98, s37, 2
    s_sub_u32 s98, 162560, s98
    s_mov_b32 s20, s8
    s_and_b32 s21, s9, 0xffff
    s_mov_b32 s22, 0xc00000
    s_mov_b32 s23, 0x00020000
    s_mov_b32 s16, s4
    s_and_b32 s17, s5, 0xffff
    s_mov_b32 s18, 0x138800
    s_mov_b32 s19, 0x00020000
    s_mov_b32 s28, s8
    s_and_b32 s29, s9, 0xffff
    s_mov_b32 s30, 0x753000
    s_mov_b32 s31, 0x00020000
    s_mov_b32 s32, s6
    s_and_b32 s33, s7, 0xffff
    s_mov_b32 s34, 0x138800
    s_mov_b32 s35, 0x00020000
    s_sub_u32 s12, s4, 3072
    s_subb_u32 s13, s5, 0
    s_and_b32 s13, s13, 0xffff
    s_or_b32 s13, s13, 0x800000
    s_mov_b32 s14, 10000
    s_mov_b32 s15, 0x00020000
    v_lshlrev_b32 v52, 2, v3
    v_and_b32 v242, 0x19, v3
    v_and_b32 v54, 2, v3
    v_and_b32 v55, 4, v3
    v_lshlrev_b32 v54, 1, v54
    v_lshrrev_b32 v55, 1, v55
    v_or3_b32 v242, v242, v54, v55
    v_lshlrev_b32 v242, 4, v242
    v_lshrrev_b32 v56, 3, v1
    v_and_b32 v243, 0x19, v56
    v_and_b32 v54, 2, v56
    v_and_b32 v55, 4, v56
    v_lshlrev_b32 v54, 1, v54
    v_lshrrev_b32 v55, 1, v55
    v_or3_b32 v243, v243, v54, v55
    v_lshl_add_u32 v243, v243, 4, 8
    v_and_b32 v57, 7, v1
    v_lshrrev_b32 v56, 1, v56
    v_xor_b32 v57, v57, v56
    v_lshlrev_b32 v57, 4, v57
    v_xor_b32 v56, 64, v57
    v_add_u32 v231, 3072, v57
    v_add_u32 v233, 2048, v56
    v_add_u32 v235, 1024, v57
    v_mov_b32 v237, v56
    v_bfe_u32 v54, v3, 1, 3
    v_xor_b32 v54, v54, v2
    v_lshlrev_b32 v54, 4, v54
    v_lshl_add_u32 v54, v3, 7, v54
    v_add_u32 v58, 87552, v54
    v_add_u32 v54, s100, v54
    v_xor_b32 v238, 0, v54
    v_xor_b32 v239, 32, v54
    v_xor_b32 v240, 64, v54
    v_xor_b32 v241, 96, v54
    v_add_u32 v244, 116224, v52
    v_lshlrev_b32 v246, 2, v1
    v_add_u32 v246, 137216, v246
    s_mov_b32 s27, 0
    s_mov_b32 s25, 0
    s_cmp_ge_u32 s26, 250
    s_cbranch_scc0 RESTART
    s_mov_b32 s25, 1
    s_branch PUBLISH
RESTART:
    v_lshlrev_b32 v9, 4, v0
    v_add_u32 v9, 136704, v9
    v_mov_b32 v10, 0
    v_mov_b32 v11, 0
    v_mov_b32 v12, 0
    v_mov_b32 v13, 0
    ds_write_b128 v9, v[10:13] offset:0
    ds_write_b128 v9, v[10:13] offset:8192
    ds_write_b128 v9, v[10:13] offset:16384
    v_cmp_gt_u32 vcc, 115, v0
    s_and_saveexec_b64 s[80:81], vcc
    ds_write_b128 v9, v[10:13] offset:24576
    s_mov_b64 exec, s[80:81]
    s_cmp_eq_u32 s27, 0
    s_cbranch_scc0 LOOKW
PUBLISH:
    s_waitcnt vmcnt(0)
    s_barrier
    s_mov_b32 s27, 1
    s_cmp_eq_u32 s36, 0
    s_cbranch_scc0 PUBD
    v_mov_b32 v40, v44
    v_mov_b32 v41, s94
    v_mov_b32 v42, v45
    v_mov_b32 v43, s94
    v_mov_b32 v48, v46
    v_mov_b32 v49, s94
    v_mov_b32 v50, v47
    v_mov_b32 v51, s94
    s_lshl_b32 s80, s26, 5
    s_add_u32 s80, s80, 8388608
    v_lshlrev_b32 v60, 13, v1
    buffer_store_dwordx4 v[40:43], v60, s[20:23], s80 offen sc1
    buffer_store_dwordx4 v[48:51], v60, s[20:23], s80 offen offset:16 sc1
PUBD:
    s_cmp_eq_u32 s25, 1
    s_cbranch_scc1 RESTART
    s_branch LOOKW2
LOOKW:
    v_mov_b32 v61, 0
LOOKW2:
    s_lshr_b32 s81, s2, 2
    s_lshl_b32 s80, s81, 13
    s_and_b32 s81, s2, 3
    s_lshl_b32 s81, s81, 3
    s_add_u32 s80, s80, s81
    s_add_u32 s80, s80, 8388608
    v_lshlrev_b32 v12, 5, v1
    v_add_u32 v12, 8004, v12
    s_mov_b64 exec, 0x3f
    s_mov_b32 s88, 0
POLL_W:
    v_cmp_eq_u32 vcc, s94, v61
    s_nop 1
    s_cmp_eq_u64 vcc, 0x3f
    s_cbranch_scc1 POLLD_W
    s_sleep 3
    buffer_load_dword v61, v12, s[20:23], s80 offen sc1
    s_add_u32 s88, s88, 1
    s_waitcnt vmcnt(0)
    s_cmp_lt_u32 s88, 0x200000
    s_cbranch_scc1 POLL_W
POLLD_W:
    s_mov_b64 exec, -1
WDISSUE:
    s_and_b32 s81, s36, 3
    s_lshl_b32 s83, s81, 7
    s_add_u32 s83, s83, 9506816
    v_lshlrev_b32 v9, 2, v3
    buffer_load_dword v251, v9, s[20:23], s83 offen
    s_cmp_eq_u32 s36, 0
    s_cbranch_scc1 WD_NONE
    v_lshlrev_b32 v10, 4, v1
    s_sub_u32 s82, s36, 1
    s_lshl_b32 s82, s82, 10
    s_add_u32 s83, s82, 9437184
    s_add_u32 s84, s82, 50688
    s_mov_b32 m0, s84
    s_add_u32 s84, s84, 7168
    buffer_load_dwordx4 v10, s[20:23], s83 offen lds
    s_add_u32 s83, s83, 7168
    s_mov_b32 m0, s84
    s_add_u32 s84, s84, 7168
    buffer_load_dwordx4 v10, s[20:23], s83 offen lds
    s_add_u32 s83, s83, 7168
    s_mov_b32 m0, s84
    s_add_u32 s84, s84, 7168
    buffer_load_dwordx4 v10, s[20:23], s83 offen lds
    s_add_u32 s83, s83, 7168
    s_mov_b32 m0, s84
    s_add_u32 s84, s84, 7168
    buffer_load_dwordx4 v10, s[20:23], s83 offen lds
    s_add_u32 s83, s83, 7168
    s_mov_b32 m0, s84
    s_add_u32 s84, s84, 7168
    buffer_load_dwordx4 v10, s[20:23], s83 offen lds
    s_add_u32 s83, s83, 7168
    s_mov_b32 m0, s84
    s_cmp_eq_u32 s36, 1
    s_cbranch_scc0 WD_X
    buffer_load_dwordx4 v10, s[20:23], s83 offen lds
    s_branch WD_Y
WD_X:
    s_cmp_eq_u32 s36, 7
    s_cbranch_scc1 WD_Y
    v_lshrrev_b32 v11, 3, v1
    v_lshrrev_b32 v12, 4, v1
    v_and_b32 v13, 7, v1
    v_xor_b32 v13, v13, v12
    v_lshlrev_b32 v13, 4, v13
    v_lshl_add_u32 v13, v11, 7, v13
    s_and_b32 s85, s36, 1
    s_lshl_b32 s85, s85, 6
    v_xor_b32 v13, s85, v13
    s_sub_u32 s82, s36, 2
    s_lshl_b32 s82, s82, 10
    s_lshl_b32 s85, s37, 7
    s_add_u32 s85, s85, s82
    v_add_u32 v13, s85, v13
    buffer_load_dwordx4 v13, s[16:19], 0 offen lds
WD_Y:
    s_waitcnt vmcnt(0)
WD_NONE:
    s_waitcnt lgkmcnt(0)
BARA:
    s_barrier
    v_lshrrev_b32 v4, 4, v1
    v_lshlrev_b32 v4, 5, v4
    v_lshrrev_b32 v8, 1, v1
    v_lshlrev_b32 v8, 5, v8
    s_lshr_b32 s81, s2, 2
    s_lshl_b32 s80, s81, 13
    s_and_b32 s81, s2, 3
    s_lshl_b32 s81, s81, 3
    s_add_u32 s80, s80, s81
    s_add_u32 s80, s80, 8388608
    s_lshl_b32 s81, s36, 10
    s_add_u32 s80, s80, s81
    buffer_load_dwordx2 v[224:225], v8, s[20:23], s80 offen sc1
    buffer_load_dwordx2 v[16:17], v4, s[20:23], s80 offen offset:0 sc1
    buffer_load_dwordx2 v[18:19], v4, s[20:23], s80 offen offset:128 sc1
    buffer_load_dwordx2 v[20:21], v4, s[20:23], s80 offen offset:256 sc1
    buffer_load_dwordx2 v[22:23], v4, s[20:23], s80 offen offset:384 sc1
    buffer_load_dwordx2 v[24:25], v4, s[20:23], s80 offen offset:512 sc1
    buffer_load_dwordx2 v[26:27], v4, s[20:23], s80 offen offset:640 sc1
    buffer_load_dwordx2 v[28:29], v4, s[20:23], s80 offen offset:768 sc1
    buffer_load_dwordx2 v[30:31], v4, s[20:23], s80 offen offset:896 sc1
    s_lshr_b32 s80, s36, 2
    s_and_b32 s81, s36, 3
    v_lshlrev_b32 v4, 4, v1
    s_lshl_b32 s82, s80, 12
    v_add_u32 v4, 50688, v4
    v_add_u32 v58, s82, v58
    s_lshl_b32 s82, s81, 10
    v_add_u32 v5, s82, v4
    v_xor_b32 v8, 0, v58
    v_xor_b32 v9, 32, v58
    v_xor_b32 v10, 64, v58
    v_xor_b32 v11, 96, v58
    ds_read_b128 v[48:51], v8
    ds_read_b128 v[208:211], v5 offset:20480
    ds_read_b128 v[52:55], v9
    ds_read_b128 v[212:215], v5 offset:24576
    ds_read_b128 v[56:59], v10
    ds_read_b128 v[216:219], v5 offset:28672
    ds_read_b128 v[60:63], v11
    ds_read_b128 v[220:223], v5 offset:32768
    ds_read_b128 v[128:131], v4 offset:0
    ds_read_b128 v[132:135], v4 offset:1024
    ds_read_b128 v[136:139], v4 offset:2048
    ds_read_b128 v[140:143], v4 offset:3072
    ds_read_b128 v[144:147], v4 offset:4096
    ds_read_b128 v[148:151], v4 offset:5120
    ds_read_b128 v[152:155], v4 offset:6144
    s_waitcnt lgkmcnt(7)
    v_mfma_f32_32x32x16_bf16 v[32:47], v[48:51], v[208:211], 0
    v_mfma_f32_32x32x16_bf16 v[32:47], v[52:55], v[212:215], v[32:47]
    v_mfma_f32_32x32x16_bf16 v[32:47], v[56:59], v[216:219], v[32:47]
    v_mfma_f32_32x32x16_bf16 v[32:47], v[60:63], v[220:223], v[32:47]
    ds_read_b128 v[156:159], v4 offset:7168
    ds_read_b128 v[160:163], v4 offset:8192
    ds_read_b128 v[164:167], v4 offset:9216
    ds_read_b128 v[168:171], v4 offset:10240
    ds_read_b128 v[172:175], v4 offset:11264
    ds_read_b128 v[176:179], v4 offset:12288
    ds_read_b128 v[180:183], v4 offset:13312
    ds_read_b128 v[184:187], v4 offset:14336
    ds_read_b128 v[188:191], v4 offset:15360
    ds_read_b128 v[192:195], v4 offset:16384
    ds_read_b128 v[196:199], v4 offset:17408
    ds_read_b128 v[200:203], v4 offset:18432
    ds_read_b128 v[204:207], v4 offset:19456
    v_lshrrev_b32 v5, 4, v1
    v_and_b32 v6, 15, v1
    v_lshrrev_b32 v7, 1, v1
    s_lshl_b32 s84, s36, 5
    s_movk_i32 s85, 2560
    v_add_u32 v14, s84, v5
    v_mad_u32_u24 v14, v14, s85, v6
    v_mul_u32_u24 v14, 12, v14
    v_and_b32 v9, 1, v1
    v_add_u32 v9, 16, v9
    v_add_u32 v13, s84, v7
    v_mad_u32_u24 v13, v13, s85, v9
    v_mul_u32_u24 v13, 12, v13
    s_mov_b32 s88, 0
POLL_T:
    s_waitcnt vmcnt(0)
    v_cmp_ne_u32 vcc, s94, v225
    v_cmp_ne_u32 s[82:83], s94, v17
    s_nop 0
    s_or_b64 vcc, vcc, s[82:83]
    v_cmp_ne_u32 s[82:83], s94, v19
    s_nop 0
    s_or_b64 vcc, vcc, s[82:83]
    v_cmp_ne_u32 s[82:83], s94, v21
    s_nop 0
    s_or_b64 vcc, vcc, s[82:83]
    v_cmp_ne_u32 s[82:83], s94, v23
    s_nop 0
    s_or_b64 vcc, vcc, s[82:83]
    v_cmp_ne_u32 s[82:83], s94, v25
    s_nop 0
    s_or_b64 vcc, vcc, s[82:83]
    v_cmp_ne_u32 s[82:83], s94, v27
    s_nop 0
    s_or_b64 vcc, vcc, s[82:83]
    v_cmp_ne_u32 s[82:83], s94, v29
    s_nop 0
    s_or_b64 vcc, vcc, s[82:83]
    v_cmp_ne_u32 s[82:83], s94, v31
    s_nop 0
    s_or_b64 vcc, vcc, s[82:83]
    s_cmp_eq_u64 vcc, 0
    s_cbranch_scc1 POLLD_T
    s_sleep 3
    v_lshrrev_b32 v4, 4, v1
    v_lshlrev_b32 v4, 5, v4
    v_lshrrev_b32 v8, 1, v1
    v_lshlrev_b32 v8, 5, v8
    s_lshr_b32 s81, s2, 2
    s_lshl_b32 s80, s81, 13
    s_and_b32 s81, s2, 3
    s_lshl_b32 s81, s81, 3
    s_add_u32 s80, s80, s81
    s_add_u32 s80, s80, 8388608
    s_lshl_b32 s81, s36, 10
    s_add_u32 s80, s80, s81
    buffer_load_dwordx2 v[224:225], v8, s[20:23], s80 offen sc1
    buffer_load_dwordx2 v[16:17], v4, s[20:23], s80 offen offset:0 sc1
    buffer_load_dwordx2 v[18:19], v4, s[20:23], s80 offen offset:128 sc1
    buffer_load_dwordx2 v[20:21], v4, s[20:23], s80 offen offset:256 sc1
    buffer_load_dwordx2 v[22:23], v4, s[20:23], s80 offen offset:384 sc1
    buffer_load_dwordx2 v[24:25], v4, s[20:23], s80 offen offset:512 sc1
    buffer_load_dwordx2 v[26:27], v4, s[20:23], s80 offen offset:640 sc1
    buffer_load_dwordx2 v[28:29], v4, s[20:23], s80 offen offset:768 sc1
    buffer_load_dwordx2 v[30:31], v4, s[20:23], s80 offen offset:896 sc1
    s_add_u32 s88, s88, 1
    s_cmp_lt_u32 s88, 0x200000
    s_cbranch_scc1 POLL_T
    s_waitcnt vmcnt(0)
POLLD_T:
    s_mov_b64 s[86:87], 0
    s_mov_b32 s96, 0
    s_bitcmp1_b32 s39, 0
    s_cbranch_scc1 QPOST
FASTREC:
    v_add_u32_sdwa v17, v16, v14 dst_sel:DWORD dst_unused:UNUSED_PAD src0_sel:WORD_0 src1_sel:DWORD
    v_cmp_gt_u32_sdwa s[40:41], v16, v6 src0_sel:WORD_1 src1_sel:DWORD
    v_add_u32_sdwa v19, v18, v14 dst_sel:DWORD dst_unused:UNUSED_PAD src0_sel:WORD_0 src1_sel:DWORD
    v_cmp_gt_u32_sdwa s[42:43], v18, v6 src0_sel:WORD_1 src1_sel:DWORD
    v_add_u32_sdwa v21, v20, v14 dst_sel:DWORD dst_unused:UNUSED_PAD src0_sel:WORD_0 src1_sel:DWORD
    v_cmp_gt_u32_sdwa s[44:45], v20, v6 src0_sel:WORD_1 src1_sel:DWORD
    v_add_u32_sdwa v23, v22, v14 dst_sel:DWORD dst_unused:UNUSED_PAD src0_sel:WORD_0 src1_sel:DWORD
    v_cmp_gt_u32_sdwa s[46:47], v22, v6 src0_sel:WORD_1 src1_sel:DWORD
    v_add_u32_sdwa v25, v24, v14 dst_sel:DWORD dst_unused:UNUSED_PAD src0_sel:WORD_0 src1_sel:DWORD
    v_cmp_gt_u32_sdwa s[48:49], v24, v6 src0_sel:WORD_1 src1_sel:DWORD
    v_add_u32_sdwa v27, v26, v14 dst_sel:DWORD dst_unused:UNUSED_PAD src0_sel:WORD_0 src1_sel:DWORD
    v_cmp_gt_u32_sdwa s[50:51], v26, v6 src0_sel:WORD_1 src1_sel:DWORD
    v_add_u32_sdwa v29, v28, v14 dst_sel:DWORD dst_unused:UNUSED_PAD src0_sel:WORD_0 src1_sel:DWORD
    v_cmp_gt_u32_sdwa s[52:53], v28, v6 src0_sel:WORD_1 src1_sel:DWORD
    v_add_u32_sdwa v31, v30, v14 dst_sel:DWORD dst_unused:UNUSED_PAD src0_sel:WORD_0 src1_sel:DWORD
    v_cmp_gt_u32_sdwa s[54:55], v30, v6 src0_sel:WORD_1 src1_sel:DWORD
    s_mov_b32 s80, 0
    s_mov_b64 exec, s[40:41]
    buffer_load_dwordx3 v[64:66], v17, s[28:31], s80 offen
    s_add_u32 s80, s80, 122880
    s_mov_b64 exec, s[42:43]
    buffer_load_dwordx3 v[68:70], v19, s[28:31], s80 offen
    s_add_u32 s80, s80, 122880
    s_mov_b64 exec, s[44:45]
    buffer_load_dwordx3 v[72:74], v21, s[28:31], s80 offen
    s_add_u32 s80, s80, 122880
    s_mov_b64 exec, s[46:47]
    buffer_load_dwordx3 v[76:78], v23, s[28:31], s80 offen
    s_add_u32 s80, s80, 122880
    s_mov_b64 exec, s[48:49]
    buffer_load_dwordx3 v[80:82], v25, s[28:31], s80 offen
    s_add_u32 s80, s80, 122880
    s_mov_b64 exec, s[50:51]
    buffer_load_dwordx3 v[84:86], v27, s[28:31], s80 offen
    s_add_u32 s80, s80, 122880
    s_mov_b64 exec, s[52:53]
    buffer_load_dwordx3 v[88:90], v29, s[28:31], s80 offen
    s_add_u32 s80, s80, 122880
    s_mov_b64 exec, s[54:55]
    buffer_load_dwordx3 v[92:94], v31, s[28:31], s80 offen
    s_mov_b64 exec, -1
    v_add_u32_sdwa v13, v224, v13 dst_sel:DWORD dst_unused:UNUSED_PAD src0_sel:WORD_0 src1_sel:DWORD
    v_lshrrev_b32 v12, 16, v224
    v_sub_u32 v12, v12, v9
    v_cmp_lt_i32 s[86:87], 16, v12
    v_cmp_lt_i32 s[56:57], 0, v12
    s_nop 0
    s_cmp_eq_u64 s[56:57], 0
    s_cbranch_scc1 SECX
    s_mov_b64 exec, s[56:57]
    buffer_load_dwordx3 v[96:98], v13, s[28:31], 0 offen offset:0
    s_mov_b64 exec, -1
    v_cmp_lt_i32 s[58:59], 2, v12
    s_nop 0
    s_cmp_eq_u64 s[58:59], 0
    s_cbranch_scc1 SECX
    s_mov_b64 exec, s[58:59]
    buffer_load_dwordx3 v[100:102], v13, s[28:31], 0 offen offset:24
    s_mov_b64 exec, -1
    v_cmp_lt_i32 s[60:61], 4, v12
    s_nop 0
    s_cmp_eq_u64 s[60:61], 0
    s_cbranch_scc1 SECX
    s_mov_b64 exec, s[60:61]
    buffer_load_dwordx3 v[104:106], v13, s[28:31], 0 offen offset:48
    s_mov_b64 exec, -1
    v_cmp_lt_i32 s[62:63], 6, v12
    s_nop 0
    s_cmp_eq_u64 s[62:63], 0
    s_cbranch_scc1 SECX
    s_mov_b64 exec, s[62:63]
    buffer_load_dwordx3 v[108:110], v13, s[28:31], 0 offen offset:72
    s_mov_b64 exec, -1
    v_cmp_lt_i32 s[64:65], 8, v12
    s_nop 0
    s_cmp_eq_u64 s[64:65], 0
    s_cbranch_scc1 SECX
    s_mov_b64 exec, s[64:65]
    buffer_load_dwordx3 v[112:114], v13, s[28:31], 0 offen offset:96
    s_mov_b64 exec, -1
    v_cmp_lt_i32 s[66:67], 10, v12
    s_nop 0
    s_cmp_eq_u64 s[66:67], 0
    s_cbranch_scc1 SECX
    s_mov_b64 exec, s[66:67]
    buffer_load_dwordx3 v[116:118], v13, s[28:31], 0 offen offset:120
    s_mov_b64 exec, -1
    v_cmp_lt_i32 s[68:69], 12, v12
    s_nop 0
    s_cmp_eq_u64 s[68:69], 0
    s_cbranch_scc1 SECX
    s_mov_b64 exec, s[68:69]
    buffer_load_dwordx3 v[120:122], v13, s[28:31], 0 offen offset:144
    s_mov_b64 exec, -1
    v_cmp_lt_i32 s[70:71], 14, v12
    s_nop 0
    s_cmp_eq_u64 s[70:71], 0
    s_cbranch_scc1 SECX
    s_mov_b64 exec, s[70:71]
    buffer_load_dwordx3 v[124:126], v13, s[28:31], 0 offen offset:168
    s_mov_b64 exec, -1
SECX:
    s_cmp_eq_u64 s[86:87], 0
    s_cbranch_scc1 NOOVF2
    v_mov_b32 v10, 163072
    v_mov_b32 v11, 1
    ds_write_b32 v10, v11
NOOVF2:
QPOST:
    s_lshr_b32 s80, s36, 2
    s_and_b32 s81, s36, 3
    s_lshl_b32 s82, s80, 14
    s_lshl_b32 s83, s81, 7
    s_add_u32 s82, s82, s83
    s_add_u32 s82, s82, 116224
    v_lshlrev_b32 v8, 2, v3
    v_lshl_add_u32 v8, v2, 11, v8
    v_add_u32 v8, s82, v8
    s_mov_b32 s83, 0xbfb8aa3b
    s_nop 3
    s_mov_b32 s84, 0x05040100
    s_mov_b32 s85, 0x07060302
    v_fma_f32 v10, v32, s83, v251
    v_fma_f32 v11, v33, s83, v251
    v_cvt_pk_bf16_f32 v12, v10, v11
    v_lshlrev_b32 v4, 16, v12
    v_and_b32 v5, 0xffff0000, v12
    v_sub_f32 v10, v10, v4
    v_sub_f32 v11, v11, v5
    v_cvt_pk_bf16_f32 v13, v10, v11
    v_perm_b32 v10, v13, v12, s84
    v_perm_b32 v11, v13, v12, s85
    ds_write_b32 v8, v10 offset:0
    ds_write_b32 v8, v11 offset:512
    v_fma_f32 v10, v34, s83, v251
    v_fma_f32 v11, v35, s83, v251
    v_cvt_pk_bf16_f32 v12, v10, v11
    v_lshlrev_b32 v4, 16, v12
    v_and_b32 v5, 0xffff0000, v12
    v_sub_f32 v10, v10, v4
    v_sub_f32 v11, v11, v5
    v_cvt_pk_bf16_f32 v13, v10, v11
    v_perm_b32 v10, v13, v12, s84
    v_perm_b32 v11, v13, v12, s85
    ds_write_b32 v8, v10 offset:1024
    ds_write_b32 v8, v11 offset:1536
    s_cmp_eq_u32 s80, 1
    s_cbranch_scc1 QDONE
    v_fma_f32 v10, v36, s83, v251
    v_fma_f32 v11, v37, s83, v251
    v_cvt_pk_bf16_f32 v12, v10, v11
    v_lshlrev_b32 v4, 16, v12
    v_and_b32 v5, 0xffff0000, v12
    v_sub_f32 v10, v10, v4
    v_sub_f32 v11, v11, v5
    v_cvt_pk_bf16_f32 v13, v10, v11
    v_perm_b32 v10, v13, v12, s84
    v_perm_b32 v11, v13, v12, s85
    ds_write_b32 v8, v10 offset:4096
    ds_write_b32 v8, v11 offset:4608
    v_fma_f32 v10, v38, s83, v251
    v_fma_f32 v11, v39, s83, v251
    v_cvt_pk_bf16_f32 v12, v10, v11
    v_lshlrev_b32 v4, 16, v12
    v_and_b32 v5, 0xffff0000, v12
    v_sub_f32 v10, v10, v4
    v_sub_f32 v11, v11, v5
    v_cvt_pk_bf16_f32 v13, v10, v11
    v_perm_b32 v10, v13, v12, s84
    v_perm_b32 v11, v13, v12, s85
    ds_write_b32 v8, v10 offset:5120
    ds_write_b32 v8, v11 offset:5632
    v_fma_f32 v10, v40, s83, v251
    v_fma_f32 v11, v41, s83, v251
    v_cvt_pk_bf16_f32 v12, v10, v11
    v_lshlrev_b32 v4, 16, v12
    v_and_b32 v5, 0xffff0000, v12
    v_sub_f32 v10, v10, v4
    v_sub_f32 v11, v11, v5
    v_cvt_pk_bf16_f32 v13, v10, v11
    v_perm_b32 v10, v13, v12, s84
    v_perm_b32 v11, v13, v12, s85
    ds_write_b32 v8, v10 offset:8192
    ds_write_b32 v8, v11 offset:8704
    v_fma_f32 v10, v42, s83, v251
    v_fma_f32 v11, v43, s83, v251
    v_cvt_pk_bf16_f32 v12, v10, v11
    v_lshlrev_b32 v4, 16, v12
    v_and_b32 v5, 0xffff0000, v12
    v_sub_f32 v10, v10, v4
    v_sub_f32 v11, v11, v5
    v_cvt_pk_bf16_f32 v13, v10, v11
    v_perm_b32 v10, v13, v12, s84
    v_perm_b32 v11, v13, v12, s85
    ds_write_b32 v8, v10 offset:9216
    ds_write_b32 v8, v11 offset:9728
    v_fma_f32 v10, v44, s83, v251
    v_fma_f32 v11, v45, s83, v251
    v_cvt_pk_bf16_f32 v12, v10, v11
    v_lshlrev_b32 v4, 16, v12
    v_and_b32 v5, 0xffff0000, v12
    v_sub_f32 v10, v10, v4
    v_sub_f32 v11, v11, v5
    v_cvt_pk_bf16_f32 v13, v10, v11
    v_perm_b32 v10, v13, v12, s84
    v_perm_b32 v11, v13, v12, s85
    ds_write_b32 v8, v10 offset:12288
    ds_write_b32 v8, v11 offset:12800
    v_fma_f32 v10, v46, s83, v251
    v_fma_f32 v11, v47, s83, v251
    v_cvt_pk_bf16_f32 v12, v10, v11
    v_lshlrev_b32 v4, 16, v12
    v_and_b32 v5, 0xffff0000, v12
    v_sub_f32 v10, v10, v4
    v_sub_f32 v11, v11, v5
    v_cvt_pk_bf16_f32 v13, v10, v11
    v_perm_b32 v10, v13, v12, s84
    v_perm_b32 v11, v13, v12, s85
    ds_write_b32 v8, v10 offset:13312
    ds_write_b32 v8, v11 offset:13824
QDONE:
    s_bitcmp1_b32 s39, 0
    s_cbranch_scc0 BATCHF
    s_waitcnt lgkmcnt(0)
    s_barrier
SLOWNEXT:
    s_lshr_b32 s81, s2, 2
    s_lshl_b32 s80, s81, 13
    s_and_b32 s81, s2, 3
    s_lshl_b32 s81, s81, 3
    s_add_u32 s80, s80, s81
    s_add_u32 s80, s80, 8388608
    s_lshl_b32 s81, s96, 5
    s_add_u32 s80, s80, s81
    v_mov_b32 v10, 0
    buffer_load_dword v11, v10, s[20:23], s80 offen sc1
    s_waitcnt vmcnt(0)
    v_readfirstlane_b32 s82, v11
    s_lshr_b32 s83, s82, 16
    s_and_b32 s82, s82, 0xffff
    s_cmp_eq_u32 s83, 0
    s_cbranch_scc1 SLOWADV
    s_mul_i32 s80, s96, 30720
    s_add_u32 s80, s80, s82
    v_mul_u32_u24 v14, 12, v0
    v_add_u32 v14, s80, v14
    v_mov_b32 v15, v0
    v_cmp_gt_u32 s[40:41], s83, v15
    s_nop 0
    s_mov_b64 exec, s[40:41]
    buffer_load_dwordx3 v[64:66], v14, s[28:31], 0 offen
    s_mov_b64 exec, -1
    v_add_u32 v14, 6144, v14
    v_add_u32 v15, 512, v15
    v_cmp_gt_u32 s[42:43], s83, v15
    s_nop 0
    s_mov_b64 exec, s[42:43]
    buffer_load_dwordx3 v[68:70], v14, s[28:31], 0 offen
    s_mov_b64 exec, -1
    v_add_u32 v14, 6144, v14
    v_add_u32 v15, 512, v15
    v_cmp_gt_u32 s[44:45], s83, v15
    s_nop 0
    s_mov_b64 exec, s[44:45]
    buffer_load_dwordx3 v[72:74], v14, s[28:31], 0 offen
    s_mov_b64 exec, -1
    v_add_u32 v14, 6144, v14
    v_add_u32 v15, 512, v15
    v_cmp_gt_u32 s[46:47], s83, v15
    s_nop 0
    s_mov_b64 exec, s[46:47]
    buffer_load_dwordx3 v[76:78], v14, s[28:31], 0 offen
    s_mov_b64 exec, -1
    v_add_u32 v14, 6144, v14
    v_add_u32 v15, 512, v15
    v_cmp_gt_u32 s[48:49], s83, v15
    s_nop 0
    s_mov_b64 exec, s[48:49]
    buffer_load_dwordx3 v[80:82], v14, s[28:31], 0 offen
    s_mov_b64 exec, -1
    v_add_u32 v14, 6144, v14
    v_add_u32 v15, 512, v15
    s_mov_b64 s[50:51], 0
    s_mov_b64 s[52:53], 0
    s_mov_b64 s[54:55], 0
    s_mov_b64 s[56:57], 0
    s_waitcnt vmcnt(0)
BATCHF:
    s_waitcnt vmcnt(0)
    v_mov_b32 v15, 1
    v_mov_b32 v62, 0x3f80
    s_mov_b32 s80, 0x3f800000
    v_add_u32_sdwa v16, v66, s98 dst_sel:DWORD dst_unused:UNUSED_PAD src0_sel:WORD_1 src1_sel:DWORD
    v_bfe_i32 v67, v66, 18, 1
    v_and_b32 v66, 0xffff, v66
    v_bfi_b32 v67, v67, s80, v62
    v_add_u32_sdwa v17, v70, s98 dst_sel:DWORD dst_unused:UNUSED_PAD src0_sel:WORD_1 src1_sel:DWORD
    v_bfe_i32 v71, v70, 18, 1
    v_and_b32 v70, 0xffff, v70
    v_bfi_b32 v71, v71, s80, v62
    v_add_u32_sdwa v18, v74, s98 dst_sel:DWORD dst_unused:UNUSED_PAD src0_sel:WORD_1 src1_sel:DWORD
    v_bfe_i32 v75, v74, 18, 1
    v_and_b32 v74, 0xffff, v74
    v_bfi_b32 v75, v75, s80, v62
    v_add_u32_sdwa v19, v78, s98 dst_sel:DWORD dst_unused:UNUSED_PAD src0_sel:WORD_1 src1_sel:DWORD
    v_bfe_i32 v79, v78, 18, 1
    v_and_b32 v78, 0xffff, v78
    v_bfi_b32 v79, v79, s80, v62
    v_add_u32_sdwa v20, v82, s98 dst_sel:DWORD dst_unused:UNUSED_PAD src0_sel:WORD_1 src1_sel:DWORD
    v_bfe_i32 v83, v82, 18, 1
    v_and_b32 v82, 0xffff, v82
    v_bfi_b32 v83, v83, s80, v62
    v_add_u32_sdwa v21, v86, s98 dst_sel:DWORD dst_unused:UNUSED_PAD src0_sel:WORD_1 src1_sel:DWORD
    v_bfe_i32 v87, v86, 18, 1
    v_and_b32 v86, 0xffff, v86
    v_bfi_b32 v87, v87, s80, v62
    v_add_u32_sdwa v22, v90, s98 dst_sel:DWORD dst_unused:UNUSED_PAD src0_sel:WORD_1 src1_sel:DWORD
    v_bfe_i32 v91, v90, 18, 1
    v_and_b32 v90, 0xffff, v90
    v_bfi_b32 v91, v91, s80, v62
    v_add_u32_sdwa v23, v94, s98 dst_sel:DWORD dst_unused:UNUSED_PAD src0_sel:WORD_1 src1_sel:DWORD
    v_bfe_i32 v95, v94, 18, 1
    v_and_b32 v94, 0xffff, v94
    v_bfi_b32 v95, v95, s80, v62
    s_mov_b64 exec, s[40:41]
    ds_add_rtn_u32 v32, v16, v15
    s_mov_b64 exec, s[42:43]
    ds_add_rtn_u32 v33, v17, v15
    s_mov_b64 exec, s[44:45]
    ds_add_rtn_u32 v34, v18, v15
    s_mov_b64 exec, s[46:47]
    ds_add_rtn_u32 v35, v19, v15
    s_mov_b64 exec, s[48:49]
    ds_add_rtn_u32 v36, v20, v15
    s_mov_b64 exec, s[50:51]
    ds_add_rtn_u32 v37, v21, v15
    s_mov_b64 exec, s[52:53]
    ds_add_rtn_u32 v38, v22, v15
    s_mov_b64 exec, s[54:55]
    ds_add_rtn_u32 v39, v23, v15
    s_mov_b64 exec, -1
    s_cmp_eq_u64 s[56:57], 0
    s_cbranch_scc1 SD_h
    v_add_u32_sdwa v24, v98, s98 dst_sel:DWORD dst_unused:UNUSED_PAD src0_sel:WORD_1 src1_sel:DWORD
    v_bfe_i32 v99, v98, 18, 1
    v_and_b32 v98, 0xffff, v98
    v_bfi_b32 v99, v99, s80, v62
    s_mov_b64 exec, s[56:57]
    ds_add_rtn_u32 v40, v24, v15
    s_mov_b64 exec, -1
    s_cmp_eq_u64 s[58:59], 0
    s_cbranch_scc1 SD_h
    v_add_u32_sdwa v25, v102, s98 dst_sel:DWORD dst_unused:UNUSED_PAD src0_sel:WORD_1 src1_sel:DWORD
    v_bfe_i32 v103, v102, 18, 1
    v_and_b32 v102, 0xffff, v102
    v_bfi_b32 v103, v103, s80, v62
    s_mov_b64 exec, s[58:59]
    ds_add_rtn_u32 v41, v25, v15
    s_mov_b64 exec, -1
    s_cmp_eq_u64 s[60:61], 0
    s_cbranch_scc1 SD_h
    v_add_u32_sdwa v26, v106, s98 dst_sel:DWORD dst_unused:UNUSED_PAD src0_sel:WORD_1 src1_sel:DWORD
    v_bfe_i32 v107, v106, 18, 1
    v_and_b32 v106, 0xffff, v106
    v_bfi_b32 v107, v107, s80, v62
    s_mov_b64 exec, s[60:61]
    ds_add_rtn_u32 v42, v26, v15
    s_mov_b64 exec, -1
    s_cmp_eq_u64 s[62:63], 0
    s_cbranch_scc1 SD_h
    v_add_u32_sdwa v27, v110, s98 dst_sel:DWORD dst_unused:UNUSED_PAD src0_sel:WORD_1 src1_sel:DWORD
    v_bfe_i32 v111, v110, 18, 1
    v_and_b32 v110, 0xffff, v110
    v_bfi_b32 v111, v111, s80, v62
    s_mov_b64 exec, s[62:63]
    ds_add_rtn_u32 v43, v27, v15
    s_mov_b64 exec, -1
    s_cmp_eq_u64 s[64:65], 0
    s_cbranch_scc1 SD_h
    v_add_u32_sdwa v28, v114, s98 dst_sel:DWORD dst_unused:UNUSED_PAD src0_sel:WORD_1 src1_sel:DWORD
    v_bfe_i32 v115, v114, 18, 1
    v_and_b32 v114, 0xffff, v114
    v_bfi_b32 v115, v115, s80, v62
    s_mov_b64 exec, s[64:65]
    ds_add_rtn_u32 v44, v28, v15
    s_mov_b64 exec, -1
    s_cmp_eq_u64 s[66:67], 0
    s_cbranch_scc1 SD_h
    v_add_u32_sdwa v29, v118, s98 dst_sel:DWORD dst_unused:UNUSED_PAD src0_sel:WORD_1 src1_sel:DWORD
    v_bfe_i32 v119, v118, 18, 1
    v_and_b32 v118, 0xffff, v118
    v_bfi_b32 v119, v119, s80, v62
    s_mov_b64 exec, s[66:67]
    ds_add_rtn_u32 v45, v29, v15
    s_mov_b64 exec, -1
    s_cmp_eq_u64 s[68:69], 0
    s_cbranch_scc1 SD_h
    v_add_u32_sdwa v30, v122, s98 dst_sel:DWORD dst_unused:UNUSED_PAD src0_sel:WORD_1 src1_sel:DWORD
    v_bfe_i32 v123, v122, 18, 1
    v_and_b32 v122, 0xffff, v122
    v_bfi_b32 v123, v123, s80, v62
    s_mov_b64 exec, s[68:69]
    ds_add_rtn_u32 v46, v30, v15
    s_mov_b64 exec, -1
    s_cmp_eq_u64 s[70:71], 0
    s_cbranch_scc1 SD_h
    v_add_u32_sdwa v31, v126, s98 dst_sel:DWORD dst_unused:UNUSED_PAD src0_sel:WORD_1 src1_sel:DWORD
    v_bfe_i32 v127, v126, 18, 1
    v_and_b32 v126, 0xffff, v126
    v_bfi_b32 v127, v127, s80, v62
    s_mov_b64 exec, s[70:71]
    ds_add_rtn_u32 v47, v31, v15
    s_mov_b64 exec, -1
SD_h:
    s_waitcnt lgkmcnt(0)
    s_barrier
    v_lshlrev_b32 v9, 2, v1
    v_add_u32 v9, 162560, v9
    v_mov_b32 v10, 163072
    ds_read_b32 v4, v9
    ds_read_b32 v11, v10
    s_waitcnt lgkmcnt(0)
    v_add_u32 v5, 3, v4
    v_and_b32 v5, 0xfffffffc, v5
    v_mov_b32 v6, v5
    v_readfirstlane_b32 s81, v11
    s_nop 1
    v_add_u32_dpp v6, v6, v6 row_shr:1 row_mask:0xf bank_mask:0xf bound_ctrl:0
    s_nop 1
    v_add_u32_dpp v6, v6, v6 row_shr:2 row_mask:0xf bank_mask:0xf bound_ctrl:0
    s_nop 1
    v_add_u32_dpp v6, v6, v6 row_shr:4 row_mask:0xf bank_mask:0xf bound_ctrl:0
    s_nop 1
    v_add_u32_dpp v6, v6, v6 row_shr:8 row_mask:0xf bank_mask:0xf bound_ctrl:0
    s_nop 1
    v_add_u32_dpp v6, v6, v6 row_bcast:15 row_mask:0xa bank_mask:0xf
    s_nop 1
    v_add_u32_dpp v6, v6, v6 row_bcast:31 row_mask:0xc bank_mask:0xf
    s_nop 1
    v_sub_u32 v7, v6, v5
    v_readlane_b32 s97, v6, 63
    s_bitcmp1_b32 s39, 0
    s_cbranch_scc1 CAPOK
    s_cmp_gt_u32 s97, 3136
    s_cbranch_scc1 GOSLOW
    s_cmp_lg_u32 s81, 0
    s_cbranch_scc1 GOSLOW
CAPOK:
    ds_bpermute_b32 v16, v16, v7
    ds_bpermute_b32 v17, v17, v7
    ds_bpermute_b32 v18, v18, v7
    ds_bpermute_b32 v19, v19, v7
    ds_bpermute_b32 v20, v20, v7
    ds_bpermute_b32 v21, v21, v7
    ds_bpermute_b32 v22, v22, v7
    ds_bpermute_b32 v23, v23, v7
    s_cmp_eq_u64 s[56:57], 0
    s_cbranch_scc1 SD_b
    ds_bpermute_b32 v24, v24, v7
    s_cmp_eq_u64 s[58:59], 0
    s_cbranch_scc1 SD_b
    ds_bpermute_b32 v25, v25, v7
    s_cmp_eq_u64 s[60:61], 0
    s_cbranch_scc1 SD_b
    ds_bpermute_b32 v26, v26, v7
    s_cmp_eq_u64 s[62:63], 0
    s_cbranch_scc1 SD_b
    ds_bpermute_b32 v27, v27, v7
    s_cmp_eq_u64 s[64:65], 0
    s_cbranch_scc1 SD_b
    ds_bpermute_b32 v28, v28, v7
    s_cmp_eq_u64 s[66:67], 0
    s_cbranch_scc1 SD_b
    ds_bpermute_b32 v29, v29, v7
    s_cmp_eq_u64 s[68:69], 0
    s_cbranch_scc1 SD_b
    ds_bpermute_b32 v30, v30, v7
    s_cmp_eq_u64 s[70:71], 0
    s_cbranch_scc1 SD_b
    ds_bpermute_b32 v31, v31, v7
SD_b:
    v_cmp_gt_u32 vcc, 32, v5
    v_cmp_gt_u32 s[82:83], s38, v1
    v_add_u32 v10, v7, v5
    s_and_b64 vcc, vcc, s[82:83]
    s_and_b32 s84, s39, 2
    s_or_b32 s84, s84, vcc_lo
    s_or_b32 s84, s84, vcc_hi
    s_mov_b32 s99, s84
    s_cmp_lg_u32 s84, 0
    s_cbranch_scc0 TDONE2
    v_lshlrev_b32 v13, 2, v1
    v_add_u32 v13, s100, v13
    v_mov_b32 v60, 0
    ds_write2st64_b32 v13, v60, v60 offset0:0 offset1:1
    s_lshr_b32 s80, s97, 2
    s_mul_i32 s81, s80, s36
    s_add_u32 s82, s81, s80
    s_lshr_b32 s81, s81, 3
    s_lshr_b32 s82, s82, 3
    s_lshl_b32 s81, s81, 2
    s_lshl_b32 s82, s82, 2
    v_max_u32 v8, s81, v7
    v_cmp_gt_u32 s[84:85], s81, v7
    v_min_u32 v10, s82, v10
    v_sub_u32 v11, v10, v8
    v_max_i32 v11, 0, v11
    v_cmp_lt_u32 vcc, 0, v11
    v_add_u32 v11, 31, v11
    v_lshrrev_b32 v11, 5, v11
    s_and_b64 s[84:85], s[84:85], vcc
    v_mov_b32 v12, v11
    s_add_u32 s86, s36, 40
    v_mov_b32 v14, s86
    v_cndmask_b32 v14, v1, v14, s[84:85]
    v_mul_u32_u24 v14, 528, v14
    v_lshlrev_b32 v14, 16, v14
    v_lshlrev_b32 v57, 9, v1
    v_lshl_or_b32 v58, v57, 16, v57
    v_or_b32 v58, 32, v58
    s_ff1_i32_b64 s86, s[84:85]
    s_lshl_b32 s87, s36, 2
    s_add_u32 s87, s87, 163088
    v_mov_b32 v63, s87
    v_mov_b32 v60, s86
    ds_write_b32 v63, v60
    s_nop 1
    v_add_u32_dpp v12, v12, v12 row_shr:1 row_mask:0xf bank_mask:0xf bound_ctrl:0
    s_nop 1
    v_add_u32_dpp v12, v12, v12 row_shr:2 row_mask:0xf bank_mask:0xf bound_ctrl:0
    s_nop 1
    v_add_u32_dpp v12, v12, v12 row_shr:4 row_mask:0xf bank_mask:0xf bound_ctrl:0
    s_nop 1
    v_add_u32_dpp v12, v12, v12 row_shr:8 row_mask:0xf bank_mask:0xf bound_ctrl:0
    s_nop 1
    v_add_u32_dpp v12, v12, v12 row_bcast:15 row_mask:0xa bank_mask:0xf
    s_nop 1
    v_add_u32_dpp v12, v12, v12 row_bcast:31 row_mask:0xc bank_mask:0xf
    s_nop 1
    v_sub_u32 v12, v12, v11
    v_lshl_add_u32 v12, v12, 2, s100
    s_mov_b32 s88, 0
TLOOP:
    v_cmp_lt_u32 vcc, s88, v11
    s_cbranch_vccz TDONE
    v_sub_u32 v60, v10, v8
    v_lshrrev_b32 v60, 2, v60
    v_min_u32 v60, 8, v60
    v_or_b32 v60, v60, v58
    v_lshl_or_b32 v56, v8, 4, v14
    s_add_u32 s89, s88, 1
    v_cmp_eq_u32 s[82:83], s89, v11
    s_and_b32 s90, s88, 3
    s_cmp_eq_u32 s90, 3
    s_cselect_b64 s[84:85], -1, 0
    s_or_b64 s[82:83], s[82:83], s[84:85]
    v_or_b32 v61, 16, v60
    v_cndmask_b32 v60, v60, v61, s[82:83]
    s_and_saveexec_b64 s[86:87], vcc
    ds_write2st64_b32 v12, v56, v60 offset0:0 offset1:1
    s_mov_b64 exec, s[86:87]
    v_add_u32 v12, 4, v12
    v_add_u32 v8, 32, v8
    s_mov_b32 s88, s89
    s_branch TLOOP
TDONE:
    ds_read_b32 v247, v13
    ds_read_b32 v245, v13 offset:256
TDONE2:
    s_cmp_gt_u32 s36, 3
    s_cbranch_scc1 NOPAD
    s_cmp_eq_u32 s36, 3
    s_cbranch_scc1 DEGACC
    v_add_u32 v12, v7, v4
    v_add_u32 v14, v7, v5
    v_add_u32 v12, s36, v12
    v_mov_b32 v56, 0
    v_mov_b32 v57, 0
    v_mov_b32 v58, 0x3fff
    v_mov_b32 v59, 0
    v_cmp_lt_u32 vcc, v12, v14
    v_lshlrev_b32 v12, 4, v12
    s_and_saveexec_b64 s[80:81], vcc
    ds_write_b128 v12, v[56:59]
    s_mov_b64 exec, s[80:81]
    s_branch NOPAD
DEGACC:
    ds_read_b32 v8, v9 offset:256
    s_waitcnt lgkmcnt(0)
    v_add_u32 v8, v8, v4
    ds_write_b32 v9, v8 offset:256
NOPAD:
    s_waitcnt lgkmcnt(0)
    v_add_lshl_u32 v16, v16, v32, 4
    v_add_lshl_u32 v17, v17, v33, 4
    v_add_lshl_u32 v18, v18, v34, 4
    v_add_lshl_u32 v19, v19, v35, 4
    v_add_lshl_u32 v20, v20, v36, 4
    v_add_lshl_u32 v21, v21, v37, 4
    v_add_lshl_u32 v22, v22, v38, 4
    v_add_lshl_u32 v23, v23, v39, 4
    s_mov_b64 exec, s[40:41]
    ds_write_b128 v16, v[64:67]
    s_mov_b64 exec, s[42:43]
    ds_write_b128 v17, v[68:71]
    s_mov_b64 exec, s[44:45]
    ds_write_b128 v18, v[72:75]
    s_mov_b64 exec, s[46:47]
    ds_write_b128 v19, v[76:79]
    s_mov_b64 exec, s[48:49]
    ds_write_b128 v20, v[80:83]
    s_mov_b64 exec, s[50:51]
    ds_write_b128 v21, v[84:87]
    s_mov_b64 exec, s[52:53]
    ds_write_b128 v22, v[88:91]
    s_mov_b64 exec, s[54:55]
    ds_write_b128 v23, v[92:95]
    s_mov_b64 exec, -1
    s_cmp_eq_u64 s[56:57], 0
    s_cbranch_scc1 SD_s
    v_add_lshl_u32 v24, v24, v40, 4
    s_mov_b64 exec, s[56:57]
    ds_write_b128 v24, v[96:99]
    s_mov_b64 exec, -1
    s_cmp_eq_u64 s[58:59], 0
    s_cbranch_scc1 SD_s
    v_add_lshl_u32 v25, v25, v41, 4
    s_mov_b64 exec, s[58:59]
    ds_write_b128 v25, v[100:103]
    s_mov_b64 exec, -1
    s_cmp_eq_u64 s[60:61], 0
    s_cbranch_scc1 SD_s
    v_add_lshl_u32 v26, v26, v42, 4
    s_mov_b64 exec, s[60:61]
    ds_write_b128 v26, v[104:107]
    s_mov_b64 exec, -1
    s_cmp_eq_u64 s[62:63], 0
    s_cbranch_scc1 SD_s
    v_add_lshl_u32 v27, v27, v43, 4
    s_mov_b64 exec, s[62:63]
    ds_write_b128 v27, v[108:111]
    s_mov_b64 exec, -1
    s_cmp_eq_u64 s[64:65], 0
    s_cbranch_scc1 SD_s
    v_add_lshl_u32 v28, v28, v44, 4
    s_mov_b64 exec, s[64:65]
    ds_write_b128 v28, v[112:115]
    s_mov_b64 exec, -1
    s_cmp_eq_u64 s[66:67], 0
    s_cbranch_scc1 SD_s
    v_add_lshl_u32 v29, v29, v45, 4
    s_mov_b64 exec, s[66:67]
    ds_write_b128 v29, v[116:119]
    s_mov_b64 exec, -1
    s_cmp_eq_u64 s[68:69], 0
    s_cbranch_scc1 SD_s
    v_add_lshl_u32 v30, v30, v46, 4
    s_mov_b64 exec, s[68:69]
    ds_write_b128 v30, v[120:123]
    s_mov_b64 exec, -1
    s_cmp_eq_u64 s[70:71], 0
    s_cbranch_scc1 SD_s
    v_add_lshl_u32 v31, v31, v47, 4
    s_mov_b64 exec, s[70:71]
    ds_write_b128 v31, v[124:127]
    s_mov_b64 exec, -1
SD_s:
    s_waitcnt vmcnt(0) lgkmcnt(0)
    s_barrier
    s_cmp_eq_u32 s36, 0
    s_cbranch_scc0 NOZH
    v_mov_b32 v14, 0
    ds_write_b32 v9, v14
NOZH:
    s_mov_b32 m0, s100
    s_cmp_lg_u32 s99, 0
    s_cbranch_scc1 FILL_SP
    s_add_u32 s80, s97, 31
    s_lshr_b32 s80, s80, 5
    s_and_b32 s83, s36, 3
    s_mul_i32 s81, s80, s83
    s_add_u32 s82, s81, s80
    s_lshr_b32 s81, s81, 2
    s_lshr_b32 s82, s82, 2
    s_add_u32 s83, s81, s82
    s_lshr_b32 s83, s83, 1
    s_cmp_ge_u32 s36, 4
    s_cselect_b32 s81, s83, s81
    s_cselect_b32 s82, s82, s83
    s_lshl_b32 s83, s81, 9
    v_add_u32 v248, s83, v243
    ds_read_b32 v230, v248 offset:0
    ds_read_b32 v232, v248 offset:128
    ds_read_b32 v234, v248 offset:256
    ds_read_b32 v236, v248 offset:384
    s_waitcnt lgkmcnt(0)
    buffer_load_dwordx4 v[230:231], s[12:15], 0 idxen offen offset:0 lds
    buffer_load_dwordx4 v[232:233], s[12:15], 0 idxen offen offset:1024 lds
    buffer_load_dwordx4 v[234:235], s[12:15], 0 idxen offen offset:2048 lds
    buffer_load_dwordx4 v[236:237], s[12:15], 0 idxen offen offset:3072 lds
    s_lshl_b32 s83, s81, 5
    v_cmp_ge_u32 vcc, s83, v7
    v_cmp_gt_u32 s[86:87], s38, v1
    v_add_u32 v12, s81, v1
    s_and_b64 vcc, vcc, s[86:87]
    s_bcnt1_i32_b64 s84, vcc
    s_sub_u32 s84, s84, 1
    v_lshlrev_b32 v56, 5, v12
    v_mov_b32 v8, s84
    v_readlane_b32 s86, v7, s84
    s_mov_b32 s85, s84
    s_add_u32 s85, s85, 1
    v_readlane_b32 s72, v7, s85
    s_add_u32 s85, s85, 1
    v_readlane_b32 s73, v7, s85
    s_add_u32 s85, s85, 1
    v_readlane_b32 s74, v7, s85
    s_add_u32 s85, s85, 1
    v_readlane_b32 s75, v7, s85
    s_add_u32 s85, s85, 1
    v_readlane_b32 s76, v7, s85
    s_add_u32 s85, s85, 1
    v_readlane_b32 s77, v7, s85
    s_add_u32 s85, s85, 1
    v_readlane_b32 s78, v7, s85
    v_add_u32 v8, 7, v8
    s_nop 0
    v_subrev_u32 v57, s72, v56
    v_lshrrev_b32 v57, 31, v57
    v_sub_u32 v8, v8, v57
    v_subrev_u32 v57, s73, v56
    v_lshrrev_b32 v57, 31, v57
    v_sub_u32 v8, v8, v57
    v_subrev_u32 v57, s74, v56
    v_lshrrev_b32 v57, 31, v57
    v_sub_u32 v8, v8, v57
    v_subrev_u32 v57, s75, v56
    v_lshrrev_b32 v57, 31, v57
    v_sub_u32 v8, v8, v57
    v_subrev_u32 v57, s76, v56
    v_lshrrev_b32 v57, 31, v57
    v_sub_u32 v8, v8, v57
    v_subrev_u32 v57, s77, v56
    v_lshrrev_b32 v57, 31, v57
    v_sub_u32 v8, v8, v57
    v_subrev_u32 v57, s78, v56
    v_lshrrev_b32 v57, 31, v57
    v_sub_u32 v8, v8, v57
    s_mov_b32 s87, s78
DA_L:
    s_lshl_b32 s88, s82, 5
    s_cmp_lt_u32 s87, s88
    s_cbranch_scc0 DA_D
    s_cmp_lt_u32 s85, s38
    s_cbranch_scc0 DA_D
    s_add_u32 s85, s85, 1
    v_readlane_b32 s87, v7, s85
    s_nop 1
    v_cmp_le_u32 vcc, s87, v56
    s_nop 1
    v_addc_co_u32 v8, vcc, 0, v8, vcc
    s_branch DA_L
DA_D:
    v_min_u32 v8, 62, v8
    v_lshlrev_b32 v57, 2, v8
    v_add_u32 v58, 4, v57
    ds_bpermute_b32 v59, v57, v7
    ds_bpermute_b32 v60, v58, v7
    s_cmp_lt_u32 s86, s83
    s_cselect_b32 s86, s84, -1
    s_cmp_lt_u32 s81, s82
    s_cselect_b32 s86, s86, -1
    s_lshl_b32 s87, s36, 2
    s_add_u32 s87, s87, 163088
    v_mov_b32 v63, s87
    v_mov_b32 v61, s86
    ds_write_b32 v63, v61
    v_lshlrev_b32 v57, 9, v8
    v_lshl_or_b32 v58, v57, 16, v57
    v_add_u32 v61, s37, v8
    v_and_b32 v61, 1, v61
    v_add_u32 v62, 0x2000000, v58
    v_add_u32 v63, 0x200, v58
    v_cmp_eq_u32 vcc, 1, v61
    s_add_u32 s88, s36, 40
    s_sub_u32 s72, s82, 1
    v_cndmask_b32 v62, v62, v63, vcc
    v_mov_b32 v63, s88
    v_cmp_gt_u32 s[84:85], s82, v12
    s_waitcnt lgkmcnt(0)
    v_cmp_gt_u32 s[90:91], s83, v59
    v_sub_u32 v57, v60, v56
    s_nop 0
    v_cndmask_b32 v63, v8, v63, s[90:91]
    v_mul_u32_u24 v63, 528, v63
    v_lshlrev_b32 v63, 16, v63
    v_lshl_or_b32 v247, v56, 4, v63
    v_cmp_gt_u32 vcc, 32, v57
    v_cmp_ne_u32 s[86:87], s97, v60
    v_lshrrev_b32 v61, 2, v57
    s_and_b64 s[82:83], vcc, s[86:87]
    v_min_u32 v61, 8, v61
    v_add_u32 v63, 8, v61
    v_cndmask_b32 v61, v61, v63, s[82:83]
    v_cndmask_b32 v58, v58, v62, s[82:83]
    v_or_b32 v61, v61, v58
    v_mov_b32 v62, v59
    v_add_u32 v59, 31, v59
    v_lshrrev_b32 v59, 5, v59
    v_sub_u32 v59, v12, v59
    v_and_b32 v59, 3, v59
    v_cmp_eq_u32 vcc, 3, v59
    v_cmp_ge_u32 s[88:89], 32, v57
    s_or_b64 vcc, vcc, s[88:89]
    s_andn2_b64 vcc, vcc, s[82:83]
    v_cmp_eq_u32 s[88:89], s72, v12
    s_or_b64 vcc, vcc, s[88:89]
    v_or_b32 v63, 16, v61
    v_cndmask_b32 v61, v61, v63, vcc
    v_cmp_eq_u32 vcc, v62, v56
    v_cmp_eq_u32 s[86:87], 0, v1
    s_or_b64 vcc, vcc, s[82:83]
    s_or_b64 vcc, vcc, s[86:87]
    v_or_b32 v63, 32, v61
    v_cndmask_b32 v61, v61, v63, vcc
    v_cndmask_b32 v245, 0, v61, s[84:85]
    v_readlane_b32 s72, v247, 0
    v_readlane_b32 s73, v245, 0
    v_readlane_b32 s74, v247, 1
    v_readlane_b32 s75, v245, 1
    v_readlane_b32 s76, v247, 2
    v_readlane_b32 s77, v245, 2
    s_mov_b32 s101, 3
    s_and_b32 s80, s73, 15
    s_cmp_eq_u32 s80, 0
    s_cbranch_scc1 MAINDONE
    s_branch FILL2
FILL_SP:
    v_readlane_b32 s72, v247, 0
    v_readlane_b32 s73, v245, 0
    v_readlane_b32 s74, v247, 1
    v_readlane_b32 s75, v245, 1
    v_readlane_b32 s76, v247, 2
    v_readlane_b32 s77, v245, 2
    s_mov_b32 s101, 3
    s_and_b32 s80, s73, 15
    s_cmp_eq_u32 s80, 0
    s_cbranch_scc1 MAINDONE
    v_add_u32_sdwa v248, s72, v243 dst_sel:DWORD dst_unused:UNUSED_PAD src0_sel:WORD_0 src1_sel:DWORD
    ds_read_b32 v230, v248 offset:0
    ds_read_b32 v232, v248 offset:128
    ds_read_b32 v234, v248 offset:256
    ds_read_b32 v236, v248 offset:384
    s_waitcnt lgkmcnt(0)
    buffer_load_dwordx4 v[230:231], s[12:15], 0 idxen offen offset:0 lds
    buffer_load_dwordx4 v[232:233], s[12:15], 0 idxen offen offset:1024 lds
    buffer_load_dwordx4 v[234:235], s[12:15], 0 idxen offen offset:2048 lds
    buffer_load_dwordx4 v[236:237], s[12:15], 0 idxen offen offset:3072 lds
FILL2:
    v_add_u32_sdwa v248, s74, v243 dst_sel:DWORD dst_unused:UNUSED_PAD src0_sel:WORD_0 src1_sel:DWORD
    ds_read_b32 v230, v248 offset:0
    ds_read_b32 v232, v248 offset:128
    ds_read_b32 v234, v248 offset:256
    ds_read_b32 v236, v248 offset:384
    v_add_u32_sdwa v249, s72, v242 dst_sel:DWORD dst_unused:UNUSED_PAD src0_sel:WORD_0 src1_sel:DWORD
    ds_read_b128 v[224:227], v249
    s_and_b32 s81, s73, 0xfe00fe00
    v_add_u32_sdwa v250, s81, v244 dst_sel:DWORD dst_unused:UNUSED_PAD src0_sel:WORD_0 src1_sel:DWORD
    v_add_u32_sdwa v40, s81, v244 dst_sel:DWORD dst_unused:UNUSED_PAD src0_sel:WORD_1 src1_sel:DWORD
    ds_read2_b32 v[44:45], v250 offset0:0 offset1:32
    ds_read2_b32 v[48:49], v40 offset0:0 offset1:32
    ds_read2_b32 v[46:47], v250 offset0:64 offset1:96
    ds_read2_b32 v[50:51], v40 offset0:64 offset1:96
    v_pk_mov_b32 v[112:113], 0, 0
    v_pk_mov_b32 v[120:121], 1.0, 1.0
    v_pk_mov_b32 v[114:115], 0, 0
    v_pk_mov_b32 v[122:123], 1.0, 1.0
    v_pk_mov_b32 v[116:117], 0, 0
    v_pk_mov_b32 v[124:125], 1.0, 1.0
    v_pk_mov_b32 v[118:119], 0, 0
    v_pk_mov_b32 v[126:127], 1.0, 1.0
    v_mov_b32 v41, 0x05040100
    v_mov_b32 v42, 0x07060302
    v_cmp_eq_u32 vcc, 1, v2
    s_getpc_b64 s[10:11]
PCREF:
    s_bitcmp1_b32 s39, 1
    s_cbranch_scc1 TB_SAFE
    s_add_u32 s10, s10, TABLE0-PCREF
    s_addc_u32 s11, s11, 0
    s_movk_i32 s3, 2048
    s_branch TB_OK
TB_SAFE:
    s_add_u32 s10, s10, TILES-PCREF
    s_addc_u32 s11, s11, 0
    s_mov_b32 s3, 0
TB_OK:
    v_cndmask_b32 v41, v41, v42, vcc
    v_cmp_ne_u32 vcc, 0, v245
    s_nop 3
    s_bcnt1_i32_b64 s80, vcc
    s_mul_i32 s80, s80, 140
    s_lshr_b32 s80, s80, 8
    s_add_u32 s95, s80, 3
    s_cmp_ge_u32 s36, 4
    s_cbranch_scc1 PR_Y
    s_setprio 1
    s_mov_b32 s95, -1
    s_branch PR_Z
PR_Y:
    s_setprio 2
PR_Z:
    s_waitcnt vmcnt(0)
    ds_read_b128 v[208:211], v238
    ds_read_b128 v[212:215], v239
    ds_read_b128 v[216:219], v240
    ds_read_b128 v[220:223], v241
    s_waitcnt lgkmcnt(0)
    v_perm_b32 v195, v48, v44, v41
    v_perm_b32 v199, v49, v45, v41
    v_perm_b32 v203, v50, v46, v41
    v_perm_b32 v207, v51, v47, v41
    buffer_load_dwordx4 v[230:231], s[12:15], 0 idxen offen offset:0 lds
    buffer_load_dwordx4 v[232:233], s[12:15], 0 idxen offen offset:1024 lds
    buffer_load_dwordx4 v[234:235], s[12:15], 0 idxen offen offset:2048 lds
    buffer_load_dwordx4 v[236:237], s[12:15], 0 idxen offen offset:3072 lds
    v_mfma_f32_32x32x16_bf16 v[64:79], v[208:211], v[128:131], 0
    v_mfma_f32_32x32x16_bf16 v[64:79], v[212:215], v[144:147], v[64:79]
    v_mfma_f32_32x32x16_bf16 v[64:79], v[216:219], v[160:163], v[64:79]
    v_mfma_f32_32x32x16_bf16 v[64:79], v[220:223], v[176:179], v[64:79]
    v_mfma_f32_32x32x16_bf16 v[64:79], v[224:227], v[192:195], v[64:79]
    s_nop 7
    s_and_b32 s84, s73, 15
    s_mul_i32 s85, s84, s3
    s_add_u32 s90, s10, s85
    s_addc_u32 s91, s11, 0
    s_setpc_b64 s[90:91]
TILES:
    s_cmp_eq_u32 s84, 0
    s_cbranch_scc1 MAINDONE
    v_mfma_f32_32x32x16_bf16 v[80:95], v[208:211], v[132:135], 0
    v_exp_f32 v96, v64
    v_exp_f32 v97, v65
    v_exp_f32 v98, v66
    v_mfma_f32_32x32x16_bf16 v[80:95], v[212:215], v[148:151], v[80:95]
    v_exp_f32 v99, v67
    v_exp_f32 v100, v68
    v_exp_f32 v101, v69
    v_mfma_f32_32x32x16_bf16 v[80:95], v[216:219], v[164:167], v[80:95]
    v_exp_f32 v102, v70
    v_exp_f32 v103, v71
    v_exp_f32 v104, v72
    v_mfma_f32_32x32x16_bf16 v[80:95], v[220:223], v[180:183], v[80:95]
    v_exp_f32 v105, v73
    v_exp_f32 v106, v74
    v_exp_f32 v107, v75
    v_mfma_f32_32x32x16_bf16 v[80:95], v[224:227], v[196:199], v[80:95]
    v_exp_f32 v108, v76
    v_exp_f32 v109, v77
    v_exp_f32 v110, v78
    v_exp_f32 v111, v79
    s_nop 0
    v_pk_add_f32 v[96:97], v[96:97], 1.0 op_sel_hi:[1,0]
    v_rcp_f32 v96, v96
    v_rcp_f32 v97, v97
    s_nop 0
    v_pk_fma_f32 v[112:113], v[64:65], v[96:97], v[112:113]
    s_cmp_eq_u32 s84, 1
    s_cbranch_scc1 SAFE_N0
    v_pk_add_f32 v[98:99], v[98:99], 1.0 op_sel_hi:[1,0]
    v_rcp_f32 v98, v98
    v_rcp_f32 v99, v99
    s_nop 0
    v_pk_fma_f32 v[112:113], v[66:67], v[98:99], v[112:113]
    s_cmp_eq_u32 s84, 2
    s_cbranch_scc1 SAFE_N0
    v_pk_add_f32 v[100:101], v[100:101], 1.0 op_sel_hi:[1,0]
    v_rcp_f32 v100, v100
    v_rcp_f32 v101, v101
    s_nop 0
    v_pk_fma_f32 v[112:113], v[68:69], v[100:101], v[112:113]
    s_cmp_eq_u32 s84, 3
    s_cbranch_scc1 SAFE_N0
    v_pk_add_f32 v[102:103], v[102:103], 1.0 op_sel_hi:[1,0]
    v_rcp_f32 v102, v102
    v_rcp_f32 v103, v103
    s_nop 0
    v_pk_fma_f32 v[112:113], v[70:71], v[102:103], v[112:113]
    s_cmp_eq_u32 s84, 4
    s_cbranch_scc1 SAFE_N0
    v_pk_add_f32 v[104:105], v[104:105], 1.0 op_sel_hi:[1,0]
    v_rcp_f32 v104, v104
    v_rcp_f32 v105, v105
    s_nop 0
    v_pk_fma_f32 v[112:113], v[72:73], v[104:105], v[112:113]
    s_cmp_eq_u32 s84, 5
    s_cbranch_scc1 SAFE_N0
    v_pk_add_f32 v[106:107], v[106:107], 1.0 op_sel_hi:[1,0]
    v_rcp_f32 v106, v106
    v_rcp_f32 v107, v107
    s_nop 0
    v_pk_fma_f32 v[112:113], v[74:75], v[106:107], v[112:113]
    s_cmp_eq_u32 s84, 6
    s_cbranch_scc1 SAFE_N0
    v_pk_add_f32 v[108:109], v[108:109], 1.0 op_sel_hi:[1,0]
    v_rcp_f32 v108, v108
    v_rcp_f32 v109, v109
    s_nop 0
    v_pk_fma_f32 v[112:113], v[76:77], v[108:109], v[112:113]
    s_cmp_eq_u32 s84, 7
    s_cbranch_scc1 SAFE_N0
    v_pk_add_f32 v[110:111], v[110:111], 1.0 op_sel_hi:[1,0]
    v_rcp_f32 v110, v110
    v_rcp_f32 v111, v111
    s_nop 0
    v_pk_fma_f32 v[112:113], v[78:79], v[110:111], v[112:113]
SAFE_N0:
    s_nop 7
    s_nop 7
    v_mfma_f32_32x32x16_bf16 v[64:79], v[208:211], v[136:139], 0
    v_exp_f32 v96, v80
    v_exp_f32 v97, v81
    v_exp_f32 v98, v82
    v_mfma_f32_32x32x16_bf16 v[64:79], v[212:215], v[152:155], v[64:79]
    v_exp_f32 v99, v83
    v_exp_f32 v100, v84
    v_exp_f32 v101, v85
    v_mfma_f32_32x32x16_bf16 v[64:79], v[216:219], v[168:171], v[64:79]
    v_exp_f32 v102, v86
    v_exp_f32 v103, v87
    v_exp_f32 v104, v88
    v_mfma_f32_32x32x16_bf16 v[64:79], v[220:223], v[184:187], v[64:79]
    v_exp_f32 v105, v89
    v_exp_f32 v106, v90
    v_exp_f32 v107, v91
    v_mfma_f32_32x32x16_bf16 v[64:79], v[224:227], v[200:203], v[64:79]
    v_exp_f32 v108, v92
    v_exp_f32 v109, v93
    v_exp_f32 v110, v94
    v_exp_f32 v111, v95
    v_add_u32_sdwa v248, s76, v243 dst_sel:DWORD dst_unused:UNUSED_PAD src0_sel:WORD_0 src1_sel:DWORD
    ds_read_b32 v230, v248 offset:0
    ds_read_b32 v232, v248 offset:128
    ds_read_b32 v234, v248 offset:256
    ds_read_b32 v236, v248 offset:384
    s_nop 0
    v_pk_add_f32 v[96:97], v[96:97], 1.0 op_sel_hi:[1,0]
    v_rcp_f32 v96, v96
    v_rcp_f32 v97, v97
    s_nop 0
    v_pk_fma_f32 v[114:115], v[80:81], v[96:97], v[114:115]
    s_cmp_eq_u32 s84, 1
    s_cbranch_scc1 SAFE_N1
    v_pk_add_f32 v[98:99], v[98:99], 1.0 op_sel_hi:[1,0]
    v_rcp_f32 v98, v98
    v_rcp_f32 v99, v99
    s_nop 0
    v_pk_fma_f32 v[114:115], v[82:83], v[98:99], v[114:115]
    s_cmp_eq_u32 s84, 2
    s_cbranch_scc1 SAFE_N1
    v_pk_add_f32 v[100:101], v[100:101], 1.0 op_sel_hi:[1,0]
    v_rcp_f32 v100, v100
    v_rcp_f32 v101, v101
    s_nop 0
    v_pk_fma_f32 v[114:115], v[84:85], v[100:101], v[114:115]
    s_cmp_eq_u32 s84, 3
    s_cbranch_scc1 SAFE_N1
    v_pk_add_f32 v[102:103], v[102:103], 1.0 op_sel_hi:[1,0]
    v_rcp_f32 v102, v102
    v_rcp_f32 v103, v103
    s_nop 0
    v_pk_fma_f32 v[114:115], v[86:87], v[102:103], v[114:115]
    s_cmp_eq_u32 s84, 4
    s_cbranch_scc1 SAFE_N1
    v_pk_add_f32 v[104:105], v[104:105], 1.0 op_sel_hi:[1,0]
    v_rcp_f32 v104, v104
    v_rcp_f32 v105, v105
    s_nop 0
    v_pk_fma_f32 v[114:115], v[88:89], v[104:105], v[114:115]
    s_cmp_eq_u32 s84, 5
    s_cbranch_scc1 SAFE_N1
    v_pk_add_f32 v[106:107], v[106:107], 1.0 op_sel_hi:[1,0]
    v_rcp_f32 v106, v106
    v_rcp_f32 v107, v107
    s_nop 0
    v_pk_fma_f32 v[114:115], v[90:91], v[106:107], v[114:115]
    s_cmp_eq_u32 s84, 6
    s_cbranch_scc1 SAFE_N1
    v_pk_add_f32 v[108:109], v[108:109], 1.0 op_sel_hi:[1,0]
    v_rcp_f32 v108, v108
    v_rcp_f32 v109, v109
    s_nop 0
    v_pk_fma_f32 v[114:115], v[92:93], v[108:109], v[114:115]
    s_cmp_eq_u32 s84, 7
    s_cbranch_scc1 SAFE_N1
    v_pk_add_f32 v[110:111], v[110:111], 1.0 op_sel_hi:[1,0]
    v_rcp_f32 v110, v110
    v_rcp_f32 v111, v111
    s_nop 0
    v_pk_fma_f32 v[114:115], v[94:95], v[110:111], v[114:115]
SAFE_N1:
    s_nop 7
    s_nop 7
    v_mfma_f32_32x32x16_bf16 v[80:95], v[208:211], v[140:143], 0
    v_exp_f32 v96, v64
    v_exp_f32 v97, v65
    v_exp_f32 v98, v66
    v_mfma_f32_32x32x16_bf16 v[80:95], v[212:215], v[156:159], v[80:95]
    v_exp_f32 v99, v67
    v_exp_f32 v100, v68
    v_exp_f32 v101, v69
    v_mfma_f32_32x32x16_bf16 v[80:95], v[216:219], v[172:175], v[80:95]
    v_exp_f32 v102, v70
    v_exp_f32 v103, v71
    v_exp_f32 v104, v72
    v_mfma_f32_32x32x16_bf16 v[80:95], v[220:223], v[188:191], v[80:95]
    v_exp_f32 v105, v73
    v_exp_f32 v106, v74
    v_exp_f32 v107, v75
    v_mfma_f32_32x32x16_bf16 v[80:95], v[224:227], v[204:207], v[80:95]
    v_exp_f32 v108, v76
    v_exp_f32 v109, v77
    v_exp_f32 v110, v78
    v_exp_f32 v111, v79
    s_waitcnt vmcnt(0)
    ds_read_b128 v[208:211], v238
    ds_read_b128 v[212:215], v239
    ds_read_b128 v[216:219], v240
    ds_read_b128 v[220:223], v241
    v_add_u32_sdwa v249, s74, v242 dst_sel:DWORD dst_unused:UNUSED_PAD src0_sel:WORD_0 src1_sel:DWORD
    ds_read_b128 v[224:227], v249
    s_bitcmp1_b32 s75, 5
    s_cbranch_scc0 NQR_ts
    s_and_b32 s81, s75, 0xfe00fe00
    v_add_u32_sdwa v250, s81, v244 dst_sel:DWORD dst_unused:UNUSED_PAD src0_sel:WORD_0 src1_sel:DWORD
    v_add_u32_sdwa v40, s81, v244 dst_sel:DWORD dst_unused:UNUSED_PAD src0_sel:WORD_1 src1_sel:DWORD
    ds_read2_b32 v[44:45], v250 offset0:0 offset1:32
    ds_read2_b32 v[48:49], v40 offset0:0 offset1:32
    ds_read2_b32 v[46:47], v250 offset0:64 offset1:96
    ds_read2_b32 v[50:51], v40 offset0:64 offset1:96
NQR_ts:
    s_nop 0
    v_pk_add_f32 v[96:97], v[96:97], 1.0 op_sel_hi:[1,0]
    v_rcp_f32 v96, v96
    v_rcp_f32 v97, v97
    s_nop 0
    v_pk_fma_f32 v[116:117], v[64:65], v[96:97], v[116:117]
    s_cmp_eq_u32 s84, 1
    s_cbranch_scc1 SAFE_N2
    v_pk_add_f32 v[98:99], v[98:99], 1.0 op_sel_hi:[1,0]
    v_rcp_f32 v98, v98
    v_rcp_f32 v99, v99
    s_nop 0
    v_pk_fma_f32 v[116:117], v[66:67], v[98:99], v[116:117]
    s_cmp_eq_u32 s84, 2
    s_cbranch_scc1 SAFE_N2
    v_pk_add_f32 v[100:101], v[100:101], 1.0 op_sel_hi:[1,0]
    v_rcp_f32 v100, v100
    v_rcp_f32 v101, v101
    s_nop 0
    v_pk_fma_f32 v[116:117], v[68:69], v[100:101], v[116:117]
    s_cmp_eq_u32 s84, 3
    s_cbranch_scc1 SAFE_N2
    v_pk_add_f32 v[102:103], v[102:103], 1.0 op_sel_hi:[1,0]
    v_rcp_f32 v102, v102
    v_rcp_f32 v103, v103
    s_nop 0
    v_pk_fma_f32 v[116:117], v[70:71], v[102:103], v[116:117]
    s_cmp_eq_u32 s84, 4
    s_cbranch_scc1 SAFE_N2
    v_pk_add_f32 v[104:105], v[104:105], 1.0 op_sel_hi:[1,0]
    v_rcp_f32 v104, v104
    v_rcp_f32 v105, v105
    s_nop 0
    v_pk_fma_f32 v[116:117], v[72:73], v[104:105], v[116:117]
    s_cmp_eq_u32 s84, 5
    s_cbranch_scc1 SAFE_N2
    v_pk_add_f32 v[106:107], v[106:107], 1.0 op_sel_hi:[1,0]
    v_rcp_f32 v106, v106
    v_rcp_f32 v107, v107
    s_nop 0
    v_pk_fma_f32 v[116:117], v[74:75], v[106:107], v[116:117]
    s_cmp_eq_u32 s84, 6
    s_cbranch_scc1 SAFE_N2
    v_pk_add_f32 v[108:109], v[108:109], 1.0 op_sel_hi:[1,0]
    v_rcp_f32 v108, v108
    v_rcp_f32 v109, v109
    s_nop 0
    v_pk_fma_f32 v[116:117], v[76:77], v[108:109], v[116:117]
    s_cmp_eq_u32 s84, 7
    s_cbranch_scc1 SAFE_N2
    v_pk_add_f32 v[110:111], v[110:111], 1.0 op_sel_hi:[1,0]
    v_rcp_f32 v110, v110
    v_rcp_f32 v111, v111
    s_nop 0
    v_pk_fma_f32 v[116:117], v[78:79], v[110:111], v[116:117]
SAFE_N2:
    s_nop 7
    s_nop 7
    s_waitcnt lgkmcnt(0)
    s_bitcmp1_b32 s75, 5
    s_cbranch_scc0 NQM_ts
    v_perm_b32 v195, v48, v44, v41
    v_perm_b32 v199, v49, v45, v41
    v_perm_b32 v203, v50, v46, v41
    v_perm_b32 v207, v51, v47, v41
NQM_ts:
    v_mfma_f32_32x32x16_bf16 v[64:79], v[208:211], v[128:131], 0
    v_exp_f32 v96, v80
    v_exp_f32 v97, v81
    v_exp_f32 v98, v82
    v_mfma_f32_32x32x16_bf16 v[64:79], v[212:215], v[144:147], v[64:79]
    v_exp_f32 v99, v83
    v_exp_f32 v100, v84
    v_exp_f32 v101, v85
    v_mfma_f32_32x32x16_bf16 v[64:79], v[216:219], v[160:163], v[64:79]
    v_exp_f32 v102, v86
    v_exp_f32 v103, v87
    v_exp_f32 v104, v88
    v_mfma_f32_32x32x16_bf16 v[64:79], v[220:223], v[176:179], v[64:79]
    v_exp_f32 v105, v89
    v_exp_f32 v106, v90
    v_exp_f32 v107, v91
    v_mfma_f32_32x32x16_bf16 v[64:79], v[224:227], v[192:195], v[64:79]
    v_exp_f32 v108, v92
    v_exp_f32 v109, v93
    v_exp_f32 v110, v94
    v_exp_f32 v111, v95
    buffer_load_dwordx4 v[230:231], s[12:15], 0 idxen offen offset:0 lds
    buffer_load_dwordx4 v[232:233], s[12:15], 0 idxen offen offset:1024 lds
    buffer_load_dwordx4 v[234:235], s[12:15], 0 idxen offen offset:2048 lds
    buffer_load_dwordx4 v[236:237], s[12:15], 0 idxen offen offset:3072 lds
    s_nop 0
    v_pk_add_f32 v[96:97], v[96:97], 1.0 op_sel_hi:[1,0]
    v_rcp_f32 v96, v96
    v_rcp_f32 v97, v97
    s_nop 0
    v_pk_fma_f32 v[118:119], v[80:81], v[96:97], v[118:119]
    s_cmp_eq_u32 s84, 1
    s_cbranch_scc1 SAFE_N3
    v_pk_add_f32 v[98:99], v[98:99], 1.0 op_sel_hi:[1,0]
    v_rcp_f32 v98, v98
    v_rcp_f32 v99, v99
    s_nop 0
    v_pk_fma_f32 v[118:119], v[82:83], v[98:99], v[118:119]
    s_cmp_eq_u32 s84, 2
    s_cbranch_scc1 SAFE_N3
    v_pk_add_f32 v[100:101], v[100:101], 1.0 op_sel_hi:[1,0]
    v_rcp_f32 v100, v100
    v_rcp_f32 v101, v101
    s_nop 0
    v_pk_fma_f32 v[118:119], v[84:85], v[100:101], v[118:119]
    s_cmp_eq_u32 s84, 3
    s_cbranch_scc1 SAFE_N3
    v_pk_add_f32 v[102:103], v[102:103], 1.0 op_sel_hi:[1,0]
    v_rcp_f32 v102, v102
    v_rcp_f32 v103, v103
    s_nop 0
    v_pk_fma_f32 v[118:119], v[86:87], v[102:103], v[118:119]
    s_cmp_eq_u32 s84, 4
    s_cbranch_scc1 SAFE_N3
    v_pk_add_f32 v[104:105], v[104:105], 1.0 op_sel_hi:[1,0]
    v_rcp_f32 v104, v104
    v_rcp_f32 v105, v105
    s_nop 0
    v_pk_fma_f32 v[118:119], v[88:89], v[104:105], v[118:119]
    s_cmp_eq_u32 s84, 5
    s_cbranch_scc1 SAFE_N3
    v_pk_add_f32 v[106:107], v[106:107], 1.0 op_sel_hi:[1,0]
    v_rcp_f32 v106, v106
    v_rcp_f32 v107, v107
    s_nop 0
    v_pk_fma_f32 v[118:119], v[90:91], v[106:107], v[118:119]
    s_cmp_eq_u32 s84, 6
    s_cbranch_scc1 SAFE_N3
    v_pk_add_f32 v[108:109], v[108:109], 1.0 op_sel_hi:[1,0]
    v_rcp_f32 v108, v108
    v_rcp_f32 v109, v109
    s_nop 0
    v_pk_fma_f32 v[118:119], v[92:93], v[108:109], v[118:119]
    s_cmp_eq_u32 s84, 7
    s_cbranch_scc1 SAFE_N3
    v_pk_add_f32 v[110:111], v[110:111], 1.0 op_sel_hi:[1,0]
    v_rcp_f32 v110, v110
    v_rcp_f32 v111, v111
    s_nop 0
    v_pk_fma_f32 v[118:119], v[94:95], v[110:111], v[118:119]
SAFE_N3:
    s_nop 7
    s_nop 7
    s_bitcmp1_b32 s73, 4
    s_cbranch_scc1 FLUSH
    s_mov_b64 s[72:73], s[74:75]
    s_mov_b64 s[74:75], s[76:77]
    v_readlane_b32 s76, v247, s101
    v_readlane_b32 s77, v245, s101
    s_add_u32 s101, s101, 1
    s_and_b32 s84, s73, 15
    s_mul_i32 s85, s84, s3
    s_add_u32 s90, s10, s85
    s_addc_u32 s91, s11, 0
    s_setpc_b64 s[90:91]
FLUSHB:
    s_lshr_b32 s81, s73, 25
    s_bfe_u32 s82, s73, 0x60009
    s_max_u32 s81, s81, s82
    s_mul_i32 s81, s81, 528
    v_add_u32 v251, s81, v246
    s_branch FLUSH2
FLUSH:
    v_add_u32_sdwa v251, s72, v246 dst_sel:DWORD dst_unused:UNUSED_PAD src0_sel:WORD_1 src1_sel:DWORD
FLUSH2:
    ds_read2st64_b32 v[252:253], v251 offset0:0 offset1:1
    v_rcp_f32 v96, v120
    v_rcp_f32 v97, v121
    v_rcp_f32 v98, v122
    v_rcp_f32 v99, v123
    v_rcp_f32 v100, v124
    v_rcp_f32 v101, v125
    v_rcp_f32 v102, v126
    v_rcp_f32 v103, v127
    v_pk_mul_f32 v[120:121], v[120:121], 0 op_sel_hi:[1,0]
    v_pk_mul_f32 v[122:123], v[122:123], 0 op_sel_hi:[1,0]
    v_pk_mul_f32 v[124:125], v[124:125], 0 op_sel_hi:[1,0]
    v_pk_mul_f32 v[126:127], v[126:127], 0 op_sel_hi:[1,0]
    v_pk_fma_f32 v[96:97], v[112:113], v[96:97], v[120:121]
    v_pk_fma_f32 v[98:99], v[114:115], v[98:99], v[122:123]
    v_pk_fma_f32 v[100:101], v[116:117], v[100:101], v[124:125]
    v_pk_fma_f32 v[102:103], v[118:119], v[102:103], v[126:127]
    v_add_f32 v32, v96, v97
    v_add_f32 v33, v98, v99
    v_add_f32 v34, v100, v101
    v_add_f32 v35, v102, v103
    v_pk_mov_b32 v[112:113], 0, 0
    v_pk_mov_b32 v[114:115], 0, 0
    v_pk_mov_b32 v[116:117], 0, 0
    v_pk_mov_b32 v[118:119], 0, 0
    v_pk_mov_b32 v[120:121], 1.0, 1.0
    v_pk_mov_b32 v[122:123], 1.0, 1.0
    v_pk_mov_b32 v[124:125], 1.0, 1.0
    v_pk_mov_b32 v[126:127], 1.0, 1.0
    v_permlane32_swap_b32 v32, v33
    v_permlane32_swap_b32 v34, v35
    v_add_f32 v32, v32, v33
    v_add_f32 v34, v34, v35
    s_waitcnt lgkmcnt(0)
    v_add_f32 v32, v32, v252
    v_add_f32 v34, v34, v253
    ds_write2st64_b32 v251, v32, v34 offset0:0 offset1:1
    s_cmp_lt_u32 s101, s95
    s_cbranch_scc1 NP_fl
    s_setprio 0
NP_fl:
    s_mov_b64 s[72:73], s[74:75]
    s_mov_b64 s[74:75], s[76:77]
    v_readlane_b32 s76, v247, s101
    v_readlane_b32 s77, v245, s101
    s_add_u32 s101, s101, 1
    s_and_b32 s84, s73, 15
    s_mul_i32 s85, s84, s3
    s_add_u32 s90, s10, s85
    s_addc_u32 s91, s11, 0
    s_setpc_b64 s[90:91]
.p2align 11
TABLE0:
    s_branch MAINDONE
.p2align 11
TILE1:
    v_mfma_f32_32x32x16_bf16 v[80:95], v[208:211], v[132:135], 0
    v_exp_f32 v96, v64
    v_exp_f32 v97, v65
    v_mfma_f32_32x32x16_bf16 v[80:95], v[212:215], v[148:151], v[80:95]
    v_mfma_f32_32x32x16_bf16 v[80:95], v[216:219], v[164:167], v[80:95]
    v_mfma_f32_32x32x16_bf16 v[80:95], v[220:223], v[180:183], v[80:95]
    v_mfma_f32_32x32x16_bf16 v[80:95], v[224:227], v[196:199], v[80:95]
    s_nop 0
    v_pk_fma_f32 v[228:229], v[112:113], v[96:97], v[112:113]
    v_pk_fma_f32 v[112:113], v[64:65], v[120:121], v[228:229]
    v_pk_fma_f32 v[120:121], v[120:121], v[96:97], v[120:121]
    s_nop 6
    v_mfma_f32_32x32x16_bf16 v[64:79], v[208:211], v[136:139], 0
    v_exp_f32 v96, v80
    v_exp_f32 v97, v81
    v_mfma_f32_32x32x16_bf16 v[64:79], v[212:215], v[152:155], v[64:79]
    v_mfma_f32_32x32x16_bf16 v[64:79], v[216:219], v[168:171], v[64:79]
    v_mfma_f32_32x32x16_bf16 v[64:79], v[220:223], v[184:187], v[64:79]
    v_mfma_f32_32x32x16_bf16 v[64:79], v[224:227], v[200:203], v[64:79]
    v_add_u32_sdwa v248, s76, v243 dst_sel:DWORD dst_unused:UNUSED_PAD src0_sel:WORD_0 src1_sel:DWORD
    ds_read_b32 v230, v248 offset:0
    ds_read_b32 v232, v248 offset:128
    ds_read_b32 v234, v248 offset:256
    ds_read_b32 v236, v248 offset:384
    v_pk_fma_f32 v[228:229], v[114:115], v[96:97], v[114:115]
    v_pk_fma_f32 v[114:115], v[80:81], v[122:123], v[228:229]
    v_pk_fma_f32 v[122:123], v[122:123], v[96:97], v[122:123]
    s_nop 2
    v_mfma_f32_32x32x16_bf16 v[80:95], v[208:211], v[140:143], 0
    v_exp_f32 v96, v64
    v_exp_f32 v97, v65
    v_mfma_f32_32x32x16_bf16 v[80:95], v[212:215], v[156:159], v[80:95]
    v_mfma_f32_32x32x16_bf16 v[80:95], v[216:219], v[172:175], v[80:95]
    v_mfma_f32_32x32x16_bf16 v[80:95], v[220:223], v[188:191], v[80:95]
    v_mfma_f32_32x32x16_bf16 v[80:95], v[224:227], v[204:207], v[80:95]
    s_waitcnt vmcnt(0)
    ds_read_b128 v[208:211], v238
    ds_read_b128 v[212:215], v239
    ds_read_b128 v[216:219], v240
    ds_read_b128 v[220:223], v241
    v_add_u32_sdwa v249, s74, v242 dst_sel:DWORD dst_unused:UNUSED_PAD src0_sel:WORD_0 src1_sel:DWORD
    ds_read_b128 v[224:227], v249
    s_bitcmp1_b32 s75, 5
    s_cbranch_scc0 NQR_t1
    s_and_b32 s81, s75, 0xfe00fe00
    v_add_u32_sdwa v250, s81, v244 dst_sel:DWORD dst_unused:UNUSED_PAD src0_sel:WORD_0 src1_sel:DWORD
    v_add_u32_sdwa v40, s81, v244 dst_sel:DWORD dst_unused:UNUSED_PAD src0_sel:WORD_1 src1_sel:DWORD
    ds_read2_b32 v[44:45], v250 offset0:0 offset1:32
    ds_read2_b32 v[48:49], v40 offset0:0 offset1:32
    ds_read2_b32 v[46:47], v250 offset0:64 offset1:96
    ds_read2_b32 v[50:51], v40 offset0:64 offset1:96
NQR_t1:
    v_pk_fma_f32 v[228:229], v[116:117], v[96:97], v[116:117]
    v_pk_fma_f32 v[116:117], v[64:65], v[124:125], v[228:229]
    v_pk_fma_f32 v[124:125], v[124:125], v[96:97], v[124:125]
    s_nop 3
    s_waitcnt lgkmcnt(0)
    s_bitcmp1_b32 s75, 5
    s_cbranch_scc0 NQM_t1
    v_perm_b32 v195, v48, v44, v41
    v_perm_b32 v199, v49, v45, v41
    v_perm_b32 v203, v50, v46, v41
    v_perm_b32 v207, v51, v47, v41
NQM_t1:
    v_mfma_f32_32x32x16_bf16 v[64:79], v[208:211], v[128:131], 0
    v_exp_f32 v96, v80
    v_exp_f32 v97, v81
    v_mfma_f32_32x32x16_bf16 v[64:79], v[212:215], v[144:147], v[64:79]
    v_mfma_f32_32x32x16_bf16 v[64:79], v[216:219], v[160:163], v[64:79]
    v_mfma_f32_32x32x16_bf16 v[64:79], v[220:223], v[176:179], v[64:79]
    v_mfma_f32_32x32x16_bf16 v[64:79], v[224:227], v[192:195], v[64:79]
    buffer_load_dwordx4 v[230:231], s[12:15], 0 idxen offen offset:0 lds
    buffer_load_dwordx4 v[232:233], s[12:15], 0 idxen offen offset:1024 lds
    buffer_load_dwordx4 v[234:235], s[12:15], 0 idxen offen offset:2048 lds
    buffer_load_dwordx4 v[236:237], s[12:15], 0 idxen offen offset:3072 lds
    v_pk_fma_f32 v[228:229], v[118:119], v[96:97], v[118:119]
    v_pk_fma_f32 v[118:119], v[80:81], v[126:127], v[228:229]
    v_pk_fma_f32 v[126:127], v[126:127], v[96:97], v[126:127]
    s_nop 3
    s_bitcmp1_b32 s73, 4
    s_cbranch_scc1 FLUSH
    s_mov_b64 s[72:73], s[74:75]
    s_mov_b64 s[74:75], s[76:77]
    v_readlane_b32 s76, v247, s101
    v_readlane_b32 s77, v245, s101
    s_add_u32 s101, s101, 1
    s_and_b32 s84, s73, 15
    s_mul_i32 s85, s84, s3
    s_add_u32 s90, s10, s85
    s_addc_u32 s91, s11, 0
    s_setpc_b64 s[90:91]
.p2align 11
TILE2:
    v_mfma_f32_32x32x16_bf16 v[80:95], v[208:211], v[132:135], 0
    v_exp_f32 v96, v64
    v_exp_f32 v97, v65
    v_exp_f32 v98, v66
    v_mfma_f32_32x32x16_bf16 v[80:95], v[212:215], v[148:151], v[80:95]
    v_exp_f32 v99, v67
    v_mfma_f32_32x32x16_bf16 v[80:95], v[216:219], v[164:167], v[80:95]
    v_mfma_f32_32x32x16_bf16 v[80:95], v[220:223], v[180:183], v[80:95]
    v_mfma_f32_32x32x16_bf16 v[80:95], v[224:227], v[196:199], v[80:95]
    s_nop 0
    v_pk_fma_f32 v[228:229], v[112:113], v[96:97], v[112:113]
    v_pk_fma_f32 v[112:113], v[64:65], v[120:121], v[228:229]
    v_pk_fma_f32 v[120:121], v[120:121], v[96:97], v[120:121]
    v_pk_fma_f32 v[228:229], v[112:113], v[98:99], v[112:113]
    v_pk_fma_f32 v[112:113], v[66:67], v[120:121], v[228:229]
    v_pk_fma_f32 v[120:121], v[120:121], v[98:99], v[120:121]
    s_nop 3
    v_mfma_f32_32x32x16_bf16 v[64:79], v[208:211], v[136:139], 0
    v_exp_f32 v96, v80
    v_exp_f32 v97, v81
    v_exp_f32 v98, v82
    v_mfma_f32_32x32x16_bf16 v[64:79], v[212:215], v[152:155], v[64:79]
    v_exp_f32 v99, v83
    v_mfma_f32_32x32x16_bf16 v[64:79], v[216:219], v[168:171], v[64:79]
    v_mfma_f32_32x32x16_bf16 v[64:79], v[220:223], v[184:187], v[64:79]
    v_mfma_f32_32x32x16_bf16 v[64:79], v[224:227], v[200:203], v[64:79]
    v_add_u32_sdwa v248, s76, v243 dst_sel:DWORD dst_unused:UNUSED_PAD src0_sel:WORD_0 src1_sel:DWORD
    ds_read_b32 v230, v248 offset:0
    ds_read_b32 v232, v248 offset:128
    ds_read_b32 v234, v248 offset:256
    ds_read_b32 v236, v248 offset:384
    v_pk_fma_f32 v[228:229], v[114:115], v[96:97], v[114:115]
    v_pk_fma_f32 v[114:115], v[80:81], v[122:123], v[228:229]
    v_pk_fma_f32 v[122:123], v[122:123], v[96:97], v[122:123]
    v_pk_fma_f32 v[228:229], v[114:115], v[98:99], v[114:115]
    v_pk_fma_f32 v[114:115], v[82:83], v[122:123], v[228:229]
    v_pk_fma_f32 v[122:123], v[122:123], v[98:99], v[122:123]
    v_mfma_f32_32x32x16_bf16 v[80:95], v[208:211], v[140:143], 0
    v_exp_f32 v96, v64
    v_exp_f32 v97, v65
    v_exp_f32 v98, v66
    v_mfma_f32_32x32x16_bf16 v[80:95], v[212:215], v[156:159], v[80:95]
    v_exp_f32 v99, v67
    v_mfma_f32_32x32x16_bf16 v[80:95], v[216:219], v[172:175], v[80:95]
    v_mfma_f32_32x32x16_bf16 v[80:95], v[220:223], v[188:191], v[80:95]
    v_mfma_f32_32x32x16_bf16 v[80:95], v[224:227], v[204:207], v[80:95]
    s_waitcnt vmcnt(0)
    ds_read_b128 v[208:211], v238
    ds_read_b128 v[212:215], v239
    ds_read_b128 v[216:219], v240
    ds_read_b128 v[220:223], v241
    v_add_u32_sdwa v249, s74, v242 dst_sel:DWORD dst_unused:UNUSED_PAD src0_sel:WORD_0 src1_sel:DWORD
    ds_read_b128 v[224:227], v249
    s_bitcmp1_b32 s75, 5
    s_cbranch_scc0 NQR_t2
    s_and_b32 s81, s75, 0xfe00fe00
    v_add_u32_sdwa v250, s81, v244 dst_sel:DWORD dst_unused:UNUSED_PAD src0_sel:WORD_0 src1_sel:DWORD
    v_add_u32_sdwa v40, s81, v244 dst_sel:DWORD dst_unused:UNUSED_PAD src0_sel:WORD_1 src1_sel:DWORD
    ds_read2_b32 v[44:45], v250 offset0:0 offset1:32
    ds_read2_b32 v[48:49], v40 offset0:0 offset1:32
    ds_read2_b32 v[46:47], v250 offset0:64 offset1:96
    ds_read2_b32 v[50:51], v40 offset0:64 offset1:96
NQR_t2:
    v_pk_fma_f32 v[228:229], v[116:117], v[96:97], v[116:117]
    v_pk_fma_f32 v[116:117], v[64:65], v[124:125], v[228:229]
    v_pk_fma_f32 v[124:125], v[124:125], v[96:97], v[124:125]
    v_pk_fma_f32 v[228:229], v[116:117], v[98:99], v[116:117]
    v_pk_fma_f32 v[116:117], v[66:67], v[124:125], v[228:229]
    v_pk_fma_f32 v[124:125], v[124:125], v[98:99], v[124:125]
    s_nop 0
    s_waitcnt lgkmcnt(0)
    s_bitcmp1_b32 s75, 5
    s_cbranch_scc0 NQM_t2
    v_perm_b32 v195, v48, v44, v41
    v_perm_b32 v199, v49, v45, v41
    v_perm_b32 v203, v50, v46, v41
    v_perm_b32 v207, v51, v47, v41
NQM_t2:
    v_mfma_f32_32x32x16_bf16 v[64:79], v[208:211], v[128:131], 0
    v_exp_f32 v96, v80
    v_exp_f32 v97, v81
    v_exp_f32 v98, v82
    v_mfma_f32_32x32x16_bf16 v[64:79], v[212:215], v[144:147], v[64:79]
    v_exp_f32 v99, v83
    v_mfma_f32_32x32x16_bf16 v[64:79], v[216:219], v[160:163], v[64:79]
    v_mfma_f32_32x32x16_bf16 v[64:79], v[220:223], v[176:179], v[64:79]
    v_mfma_f32_32x32x16_bf16 v[64:79], v[224:227], v[192:195], v[64:79]
    buffer_load_dwordx4 v[230:231], s[12:15], 0 idxen offen offset:0 lds
    buffer_load_dwordx4 v[232:233], s[12:15], 0 idxen offen offset:1024 lds
    buffer_load_dwordx4 v[234:235], s[12:15], 0 idxen offen offset:2048 lds
    buffer_load_dwordx4 v[236:237], s[12:15], 0 idxen offen offset:3072 lds
    v_pk_fma_f32 v[228:229], v[118:119], v[96:97], v[118:119]
    v_pk_fma_f32 v[118:119], v[80:81], v[126:127], v[228:229]
    v_pk_fma_f32 v[126:127], v[126:127], v[96:97], v[126:127]
    v_pk_fma_f32 v[228:229], v[118:119], v[98:99], v[118:119]
    v_pk_fma_f32 v[118:119], v[82:83], v[126:127], v[228:229]
    v_pk_fma_f32 v[126:127], v[126:127], v[98:99], v[126:127]
    s_nop 0
    s_bitcmp1_b32 s73, 4
    s_cbranch_scc1 FLUSH
    s_mov_b64 s[72:73], s[74:75]
    s_mov_b64 s[74:75], s[76:77]
    v_readlane_b32 s76, v247, s101
    v_readlane_b32 s77, v245, s101
    s_add_u32 s101, s101, 1
    s_and_b32 s84, s73, 15
    s_mul_i32 s85, s84, s3
    s_add_u32 s90, s10, s85
    s_addc_u32 s91, s11, 0
    s_setpc_b64 s[90:91]
.p2align 11
TILE3:
    v_mfma_f32_32x32x16_bf16 v[80:95], v[208:211], v[132:135], 0
    v_exp_f32 v96, v64
    v_exp_f32 v97, v65
    v_exp_f32 v98, v66
    v_mfma_f32_32x32x16_bf16 v[80:95], v[212:215], v[148:151], v[80:95]
    v_exp_f32 v99, v67
    v_exp_f32 v100, v68
    v_exp_f32 v101, v69
    v_mfma_f32_32x32x16_bf16 v[80:95], v[216:219], v[164:167], v[80:95]
    v_mfma_f32_32x32x16_bf16 v[80:95], v[220:223], v[180:183], v[80:95]
    v_mfma_f32_32x32x16_bf16 v[80:95], v[224:227], v[196:199], v[80:95]
    s_nop 0
    v_pk_fma_f32 v[228:229], v[112:113], v[96:97], v[112:113]
    v_pk_fma_f32 v[112:113], v[64:65], v[120:121], v[228:229]
    v_pk_fma_f32 v[120:121], v[120:121], v[96:97], v[120:121]
    v_pk_fma_f32 v[228:229], v[112:113], v[98:99], v[112:113]
    v_pk_fma_f32 v[112:113], v[66:67], v[120:121], v[228:229]
    v_pk_fma_f32 v[120:121], v[120:121], v[98:99], v[120:121]
    v_pk_fma_f32 v[228:229], v[112:113], v[100:101], v[112:113]
    v_pk_fma_f32 v[112:113], v[68:69], v[120:121], v[228:229]
    v_pk_fma_f32 v[120:121], v[120:121], v[100:101], v[120:121]
    s_nop 0
    v_mfma_f32_32x32x16_bf16 v[64:79], v[208:211], v[136:139], 0
    v_exp_f32 v96, v80
    v_exp_f32 v97, v81
    v_exp_f32 v98, v82
    v_mfma_f32_32x32x16_bf16 v[64:79], v[212:215], v[152:155], v[64:79]
    v_exp_f32 v99, v83
    v_exp_f32 v100, v84
    v_exp_f32 v101, v85
    v_mfma_f32_32x32x16_bf16 v[64:79], v[216:219], v[168:171], v[64:79]
    v_mfma_f32_32x32x16_bf16 v[64:79], v[220:223], v[184:187], v[64:79]
    v_mfma_f32_32x32x16_bf16 v[64:79], v[224:227], v[200:203], v[64:79]
    v_add_u32_sdwa v248, s76, v243 dst_sel:DWORD dst_unused:UNUSED_PAD src0_sel:WORD_0 src1_sel:DWORD
    ds_read_b32 v230, v248 offset:0
    ds_read_b32 v232, v248 offset:128
    ds_read_b32 v234, v248 offset:256
    ds_read_b32 v236, v248 offset:384
    v_pk_fma_f32 v[228:229], v[114:115], v[96:97], v[114:115]
    v_pk_fma_f32 v[114:115], v[80:81], v[122:123], v[228:229]
    v_pk_fma_f32 v[122:123], v[122:123], v[96:97], v[122:123]
    v_pk_fma_f32 v[228:229], v[114:115], v[98:99], v[114:115]
    v_pk_fma_f32 v[114:115], v[82:83], v[122:123], v[228:229]
    v_pk_fma_f32 v[122:123], v[122:123], v[98:99], v[122:123]
    v_pk_fma_f32 v[228:229], v[114:115], v[100:101], v[114:115]
    v_pk_fma_f32 v[114:115], v[84:85], v[122:123], v[228:229]
    v_pk_fma_f32 v[122:123], v[122:123], v[100:101], v[122:123]
    v_mfma_f32_32x32x16_bf16 v[80:95], v[208:211], v[140:143], 0
    v_exp_f32 v96, v64
    v_exp_f32 v97, v65
    v_exp_f32 v98, v66
    v_mfma_f32_32x32x16_bf16 v[80:95], v[212:215], v[156:159], v[80:95]
    v_exp_f32 v99, v67
    v_exp_f32 v100, v68
    v_exp_f32 v101, v69
    v_mfma_f32_32x32x16_bf16 v[80:95], v[216:219], v[172:175], v[80:95]
    v_mfma_f32_32x32x16_bf16 v[80:95], v[220:223], v[188:191], v[80:95]
    v_mfma_f32_32x32x16_bf16 v[80:95], v[224:227], v[204:207], v[80:95]
    s_waitcnt vmcnt(0)
    ds_read_b128 v[208:211], v238
    ds_read_b128 v[212:215], v239
    ds_read_b128 v[216:219], v240
    ds_read_b128 v[220:223], v241
    v_add_u32_sdwa v249, s74, v242 dst_sel:DWORD dst_unused:UNUSED_PAD src0_sel:WORD_0 src1_sel:DWORD
    ds_read_b128 v[224:227], v249
    s_bitcmp1_b32 s75, 5
    s_cbranch_scc0 NQR_t3
    s_and_b32 s81, s75, 0xfe00fe00
    v_add_u32_sdwa v250, s81, v244 dst_sel:DWORD dst_unused:UNUSED_PAD src0_sel:WORD_0 src1_sel:DWORD
    v_add_u32_sdwa v40, s81, v244 dst_sel:DWORD dst_unused:UNUSED_PAD src0_sel:WORD_1 src1_sel:DWORD
    ds_read2_b32 v[44:45], v250 offset0:0 offset1:32
    ds_read2_b32 v[48:49], v40 offset0:0 offset1:32
    ds_read2_b32 v[46:47], v250 offset0:64 offset1:96
    ds_read2_b32 v[50:51], v40 offset0:64 offset1:96
NQR_t3:
    v_pk_fma_f32 v[228:229], v[116:117], v[96:97], v[116:117]
    v_pk_fma_f32 v[116:117], v[64:65], v[124:125], v[228:229]
    v_pk_fma_f32 v[124:125], v[124:125], v[96:97], v[124:125]
    v_pk_fma_f32 v[228:229], v[116:117], v[98:99], v[116:117]
    v_pk_fma_f32 v[116:117], v[66:67], v[124:125], v[228:229]
    v_pk_fma_f32 v[124:125], v[124:125], v[98:99], v[124:125]
    v_pk_fma_f32 v[228:229], v[116:117], v[100:101], v[116:117]
    v_pk_fma_f32 v[116:117], v[68:69], v[124:125], v[228:229]
    v_pk_fma_f32 v[124:125], v[124:125], v[100:101], v[124:125]
    s_waitcnt lgkmcnt(0)
    s_bitcmp1_b32 s75, 5
    s_cbranch_scc0 NQM_t3
    v_perm_b32 v195, v48, v44, v41
    v_perm_b32 v199, v49, v45, v41
    v_perm_b32 v203, v50, v46, v41
    v_perm_b32 v207, v51, v47, v41
NQM_t3:
    v_mfma_f32_32x32x16_bf16 v[64:79], v[208:211], v[128:131], 0
    v_exp_f32 v96, v80
    v_exp_f32 v97, v81
    v_exp_f32 v98, v82
    v_mfma_f32_32x32x16_bf16 v[64:79], v[212:215], v[144:147], v[64:79]
    v_exp_f32 v99, v83
    v_exp_f32 v100, v84
    v_exp_f32 v101, v85
    v_mfma_f32_32x32x16_bf16 v[64:79], v[216:219], v[160:163], v[64:79]
    v_mfma_f32_32x32x16_bf16 v[64:79], v[220:223], v[176:179], v[64:79]
    v_mfma_f32_32x32x16_bf16 v[64:79], v[224:227], v[192:195], v[64:79]
    buffer_load_dwordx4 v[230:231], s[12:15], 0 idxen offen offset:0 lds
    buffer_load_dwordx4 v[232:233], s[12:15], 0 idxen offen offset:1024 lds
    buffer_load_dwordx4 v[234:235], s[12:15], 0 idxen offen offset:2048 lds
    buffer_load_dwordx4 v[236:237], s[12:15], 0 idxen offen offset:3072 lds
    v_pk_fma_f32 v[228:229], v[118:119], v[96:97], v[118:119]
    v_pk_fma_f32 v[118:119], v[80:81], v[126:127], v[228:229]
    v_pk_fma_f32 v[126:127], v[126:127], v[96:97], v[126:127]
    v_pk_fma_f32 v[228:229], v[118:119], v[98:99], v[118:119]
    v_pk_fma_f32 v[118:119], v[82:83], v[126:127], v[228:229]
    v_pk_fma_f32 v[126:127], v[126:127], v[98:99], v[126:127]
    v_pk_fma_f32 v[228:229], v[118:119], v[100:101], v[118:119]
    v_pk_fma_f32 v[118:119], v[84:85], v[126:127], v[228:229]
    v_pk_fma_f32 v[126:127], v[126:127], v[100:101], v[126:127]
    s_bitcmp1_b32 s73, 4
    s_cbranch_scc1 FLUSH
    s_mov_b64 s[72:73], s[74:75]
    s_mov_b64 s[74:75], s[76:77]
    v_readlane_b32 s76, v247, s101
    v_readlane_b32 s77, v245, s101
    s_add_u32 s101, s101, 1
    s_and_b32 s84, s73, 15
    s_mul_i32 s85, s84, s3
    s_add_u32 s90, s10, s85
    s_addc_u32 s91, s11, 0
    s_setpc_b64 s[90:91]
.p2align 11
TILE4:
    v_mfma_f32_32x32x16_bf16 v[80:95], v[208:211], v[132:135], 0
    v_exp_f32 v96, v64
    v_exp_f32 v97, v65
    v_exp_f32 v98, v66
    v_mfma_f32_32x32x16_bf16 v[80:95], v[212:215], v[148:151], v[80:95]
    v_exp_f32 v99, v67
    v_exp_f32 v100, v68
    v_exp_f32 v101, v69
    v_mfma_f32_32x32x16_bf16 v[80:95], v[216:219], v[164:167], v[80:95]
    v_exp_f32 v102, v70
    v_exp_f32 v103, v71
    v_mfma_f32_32x32x16_bf16 v[80:95], v[220:223], v[180:183], v[80:95]
    v_mfma_f32_32x32x16_bf16 v[80:95], v[224:227], v[196:199], v[80:95]
    s_nop 0
    v_pk_fma_f32 v[228:229], v[112:113], v[96:97], v[112:113]
    v_pk_fma_f32 v[112:113], v[64:65], v[120:121], v[228:229]
    v_pk_fma_f32 v[120:121], v[120:121], v[96:97], v[120:121]
    v_pk_fma_f32 v[228:229], v[112:113], v[98:99], v[112:113]
    v_pk_fma_f32 v[112:113], v[66:67], v[120:121], v[228:229]
    v_pk_fma_f32 v[120:121], v[120:121], v[98:99], v[120:121]
    v_pk_fma_f32 v[228:229], v[112:113], v[100:101], v[112:113]
    v_pk_fma_f32 v[112:113], v[68:69], v[120:121], v[228:229]
    v_pk_fma_f32 v[120:121], v[120:121], v[100:101], v[120:121]
    v_pk_fma_f32 v[228:229], v[112:113], v[102:103], v[112:113]
    v_pk_fma_f32 v[112:113], v[70:71], v[120:121], v[228:229]
    v_pk_fma_f32 v[120:121], v[120:121], v[102:103], v[120:121]
    v_mfma_f32_32x32x16_bf16 v[64:79], v[208:211], v[136:139], 0
    v_exp_f32 v96, v80
    v_exp_f32 v97, v81
    v_exp_f32 v98, v82
    v_mfma_f32_32x32x16_bf16 v[64:79], v[212:215], v[152:155], v[64:79]
    v_exp_f32 v99, v83
    v_exp_f32 v100, v84
    v_exp_f32 v101, v85
    v_mfma_f32_32x32x16_bf16 v[64:79], v[216:219], v[168:171], v[64:79]
    v_exp_f32 v102, v86
    v_exp_f32 v103, v87
    v_mfma_f32_32x32x16_bf16 v[64:79], v[220:223], v[184:187], v[64:79]
    v_mfma_f32_32x32x16_bf16 v[64:79], v[224:227], v[200:203], v[64:79]
    v_add_u32_sdwa v248, s76, v243 dst_sel:DWORD dst_unused:UNUSED_PAD src0_sel:WORD_0 src1_sel:DWORD
    ds_read_b32 v230, v248 offset:0
    ds_read_b32 v232, v248 offset:128
    ds_read_b32 v234, v248 offset:256
    ds_read_b32 v236, v248 offset:384
    v_pk_fma_f32 v[228:229], v[114:115], v[96:97], v[114:115]
    v_pk_fma_f32 v[114:115], v[80:81], v[122:123], v[228:229]
    v_pk_fma_f32 v[122:123], v[122:123], v[96:97], v[122:123]
    v_pk_fma_f32 v[228:229], v[114:115], v[98:99], v[114:115]
    v_pk_fma_f32 v[114:115], v[82:83], v[122:123], v[228:229]
    v_pk_fma_f32 v[122:123], v[122:123], v[98:99], v[122:123]
    v_pk_fma_f32 v[228:229], v[114:115], v[100:101], v[114:115]
    v_pk_fma_f32 v[114:115], v[84:85], v[122:123], v[228:229]
    v_pk_fma_f32 v[122:123], v[122:123], v[100:101], v[122:123]
    v_pk_fma_f32 v[228:229], v[114:115], v[102:103], v[114:115]
    v_pk_fma_f32 v[114:115], v[86:87], v[122:123], v[228:229]
    v_pk_fma_f32 v[122:123], v[122:123], v[102:103], v[122:123]
    v_mfma_f32_32x32x16_bf16 v[80:95], v[208:211], v[140:143], 0
    v_exp_f32 v96, v64
    v_exp_f32 v97, v65
    v_exp_f32 v98, v66
    v_mfma_f32_32x32x16_bf16 v[80:95], v[212:215], v[156:159], v[80:95]
    v_exp_f32 v99, v67
    v_exp_f32 v100, v68
    v_exp_f32 v101, v69
    v_mfma_f32_32x32x16_bf16 v[80:95], v[216:219], v[172:175], v[80:95]
    v_exp_f32 v102, v70
    v_exp_f32 v103, v71
    v_mfma_f32_32x32x16_bf16 v[80:95], v[220:223], v[188:191], v[80:95]
    v_mfma_f32_32x32x16_bf16 v[80:95], v[224:227], v[204:207], v[80:95]
    s_waitcnt vmcnt(0)
    ds_read_b128 v[208:211], v238
    ds_read_b128 v[212:215], v239
    ds_read_b128 v[216:219], v240
    ds_read_b128 v[220:223], v241
    v_add_u32_sdwa v249, s74, v242 dst_sel:DWORD dst_unused:UNUSED_PAD src0_sel:WORD_0 src1_sel:DWORD
    ds_read_b128 v[224:227], v249
    s_bitcmp1_b32 s75, 5
    s_cbranch_scc0 NQR_t4
    s_and_b32 s81, s75, 0xfe00fe00
    v_add_u32_sdwa v250, s81, v244 dst_sel:DWORD dst_unused:UNUSED_PAD src0_sel:WORD_0 src1_sel:DWORD
    v_add_u32_sdwa v40, s81, v244 dst_sel:DWORD dst_unused:UNUSED_PAD src0_sel:WORD_1 src1_sel:DWORD
    ds_read2_b32 v[44:45], v250 offset0:0 offset1:32
    ds_read2_b32 v[48:49], v40 offset0:0 offset1:32
    ds_read2_b32 v[46:47], v250 offset0:64 offset1:96
    ds_read2_b32 v[50:51], v40 offset0:64 offset1:96
NQR_t4:
    v_pk_fma_f32 v[228:229], v[116:117], v[96:97], v[116:117]
    v_pk_fma_f32 v[116:117], v[64:65], v[124:125], v[228:229]
    v_pk_fma_f32 v[124:125], v[124:125], v[96:97], v[124:125]
    v_pk_fma_f32 v[228:229], v[116:117], v[98:99], v[116:117]
    v_pk_fma_f32 v[116:117], v[66:67], v[124:125], v[228:229]
    v_pk_fma_f32 v[124:125], v[124:125], v[98:99], v[124:125]
    v_pk_fma_f32 v[228:229], v[116:117], v[100:101], v[116:117]
    v_pk_fma_f32 v[116:117], v[68:69], v[124:125], v[228:229]
    v_pk_fma_f32 v[124:125], v[124:125], v[100:101], v[124:125]
    v_pk_fma_f32 v[228:229], v[116:117], v[102:103], v[116:117]
    v_pk_fma_f32 v[116:117], v[70:71], v[124:125], v[228:229]
    v_pk_fma_f32 v[124:125], v[124:125], v[102:103], v[124:125]
    s_waitcnt lgkmcnt(0)
    s_bitcmp1_b32 s75, 5
    s_cbranch_scc0 NQM_t4
    v_perm_b32 v195, v48, v44, v41
    v_perm_b32 v199, v49, v45, v41
    v_perm_b32 v203, v50, v46, v41
    v_perm_b32 v207, v51, v47, v41
NQM_t4:
    v_mfma_f32_32x32x16_bf16 v[64:79], v[208:211], v[128:131], 0
    v_exp_f32 v96, v80
    v_exp_f32 v97, v81
    v_exp_f32 v98, v82
    v_mfma_f32_32x32x16_bf16 v[64:79], v[212:215], v[144:147], v[64:79]
    v_exp_f32 v99, v83
    v_exp_f32 v100, v84
    v_exp_f32 v101, v85
    v_mfma_f32_32x32x16_bf16 v[64:79], v[216:219], v[160:163], v[64:79]
    v_exp_f32 v102, v86
    v_exp_f32 v103, v87
    v_mfma_f32_32x32x16_bf16 v[64:79], v[220:223], v[176:179], v[64:79]
    v_mfma_f32_32x32x16_bf16 v[64:79], v[224:227], v[192:195], v[64:79]
    buffer_load_dwordx4 v[230:231], s[12:15], 0 idxen offen offset:0 lds
    buffer_load_dwordx4 v[232:233], s[12:15], 0 idxen offen offset:1024 lds
    buffer_load_dwordx4 v[234:235], s[12:15], 0 idxen offen offset:2048 lds
    buffer_load_dwordx4 v[236:237], s[12:15], 0 idxen offen offset:3072 lds
    v_pk_fma_f32 v[228:229], v[118:119], v[96:97], v[118:119]
    v_pk_fma_f32 v[118:119], v[80:81], v[126:127], v[228:229]
    v_pk_fma_f32 v[126:127], v[126:127], v[96:97], v[126:127]
    v_pk_fma_f32 v[228:229], v[118:119], v[98:99], v[118:119]
    v_pk_fma_f32 v[118:119], v[82:83], v[126:127], v[228:229]
    v_pk_fma_f32 v[126:127], v[126:127], v[98:99], v[126:127]
    v_pk_fma_f32 v[228:229], v[118:119], v[100:101], v[118:119]
    v_pk_fma_f32 v[118:119], v[84:85], v[126:127], v[228:229]
    v_pk_fma_f32 v[126:127], v[126:127], v[100:101], v[126:127]
    v_pk_fma_f32 v[228:229], v[118:119], v[102:103], v[118:119]
    v_pk_fma_f32 v[118:119], v[86:87], v[126:127], v[228:229]
    v_pk_fma_f32 v[126:127], v[126:127], v[102:103], v[126:127]
    s_bitcmp1_b32 s73, 4
    s_cbranch_scc1 FLUSH
    s_mov_b64 s[72:73], s[74:75]
    s_mov_b64 s[74:75], s[76:77]
    v_readlane_b32 s76, v247, s101
    v_readlane_b32 s77, v245, s101
    s_add_u32 s101, s101, 1
    s_and_b32 s84, s73, 15
    s_mul_i32 s85, s84, s3
    s_add_u32 s90, s10, s85
    s_addc_u32 s91, s11, 0
    s_setpc_b64 s[90:91]
.p2align 11
TILE5:
    v_mfma_f32_32x32x16_bf16 v[80:95], v[208:211], v[132:135], 0
    v_exp_f32 v96, v64
    v_exp_f32 v97, v65
    v_exp_f32 v98, v66
    v_mfma_f32_32x32x16_bf16 v[80:95], v[212:215], v[148:151], v[80:95]
    v_exp_f32 v99, v67
    v_exp_f32 v100, v68
    v_exp_f32 v101, v69
    v_mfma_f32_32x32x16_bf16 v[80:95], v[216:219], v[164:167], v[80:95]
    v_exp_f32 v102, v70
    v_exp_f32 v103, v71
    v_exp_f32 v104, v72
    v_mfma_f32_32x32x16_bf16 v[80:95], v[220:223], v[180:183], v[80:95]
    v_exp_f32 v105, v73
    v_mfma_f32_32x32x16_bf16 v[80:95], v[224:227], v[196:199], v[80:95]
    s_nop 0
    v_pk_fma_f32 v[228:229], v[112:113], v[96:97], v[112:113]
    v_pk_fma_f32 v[112:113], v[64:65], v[120:121], v[228:229]
    v_pk_fma_f32 v[120:121], v[120:121], v[96:97], v[120:121]
    v_pk_fma_f32 v[228:229], v[112:113], v[98:99], v[112:113]
    v_pk_fma_f32 v[112:113], v[66:67], v[120:121], v[228:229]
    v_pk_fma_f32 v[120:121], v[120:121], v[98:99], v[120:121]
    v_pk_fma_f32 v[228:229], v[112:113], v[100:101], v[112:113]
    v_pk_fma_f32 v[112:113], v[68:69], v[120:121], v[228:229]
    v_pk_fma_f32 v[120:121], v[120:121], v[100:101], v[120:121]
    v_pk_fma_f32 v[228:229], v[112:113], v[102:103], v[112:113]
    v_pk_fma_f32 v[112:113], v[70:71], v[120:121], v[228:229]
    v_pk_fma_f32 v[120:121], v[120:121], v[102:103], v[120:121]
    v_pk_fma_f32 v[228:229], v[112:113], v[104:105], v[112:113]
    v_pk_fma_f32 v[112:113], v[72:73], v[120:121], v[228:229]
    v_pk_fma_f32 v[120:121], v[120:121], v[104:105], v[120:121]
    v_mfma_f32_32x32x16_bf16 v[64:79], v[208:211], v[136:139], 0
    v_exp_f32 v96, v80
    v_exp_f32 v97, v81
    v_exp_f32 v98, v82
    v_mfma_f32_32x32x16_bf16 v[64:79], v[212:215], v[152:155], v[64:79]
    v_exp_f32 v99, v83
    v_exp_f32 v100, v84
    v_exp_f32 v101, v85
    v_mfma_f32_32x32x16_bf16 v[64:79], v[216:219], v[168:171], v[64:79]
    v_exp_f32 v102, v86
    v_exp_f32 v103, v87
    v_exp_f32 v104, v88
    v_mfma_f32_32x32x16_bf16 v[64:79], v[220:223], v[184:187], v[64:79]
    v_exp_f32 v105, v89
    v_mfma_f32_32x32x16_bf16 v[64:79], v[224:227], v[200:203], v[64:79]
    v_add_u32_sdwa v248, s76, v243 dst_sel:DWORD dst_unused:UNUSED_PAD src0_sel:WORD_0 src1_sel:DWORD
    ds_read_b32 v230, v248 offset:0
    ds_read_b32 v232, v248 offset:128
    ds_read_b32 v234, v248 offset:256
    ds_read_b32 v236, v248 offset:384
    v_pk_fma_f32 v[228:229], v[114:115], v[96:97], v[114:115]
    v_pk_fma_f32 v[114:115], v[80:81], v[122:123], v[228:229]
    v_pk_fma_f32 v[122:123], v[122:123], v[96:97], v[122:123]
    v_pk_fma_f32 v[228:229], v[114:115], v[98:99], v[114:115]
    v_pk_fma_f32 v[114:115], v[82:83], v[122:123], v[228:229]
    v_pk_fma_f32 v[122:123], v[122:123], v[98:99], v[122:123]
    v_pk_fma_f32 v[228:229], v[114:115], v[100:101], v[114:115]
    v_pk_fma_f32 v[114:115], v[84:85], v[122:123], v[228:229]
    v_pk_fma_f32 v[122:123], v[122:123], v[100:101], v[122:123]
    v_pk_fma_f32 v[228:229], v[114:115], v[102:103], v[114:115]
    v_pk_fma_f32 v[114:115], v[86:87], v[122:123], v[228:229]
    v_pk_fma_f32 v[122:123], v[122:123], v[102:103], v[122:123]
    v_pk_fma_f32 v[228:229], v[114:115], v[104:105], v[114:115]
    v_pk_fma_f32 v[114:115], v[88:89], v[122:123], v[228:229]
    v_pk_fma_f32 v[122:123], v[122:123], v[104:105], v[122:123]
    v_mfma_f32_32x32x16_bf16 v[80:95], v[208:211], v[140:143], 0
    v_exp_f32 v96, v64
    v_exp_f32 v97, v65
    v_exp_f32 v98, v66
    v_mfma_f32_32x32x16_bf16 v[80:95], v[212:215], v[156:159], v[80:95]
    v_exp_f32 v99, v67
    v_exp_f32 v100, v68
    v_exp_f32 v101, v69
    v_mfma_f32_32x32x16_bf16 v[80:95], v[216:219], v[172:175], v[80:95]
    v_exp_f32 v102, v70
    v_exp_f32 v103, v71
    v_exp_f32 v104, v72
    v_mfma_f32_32x32x16_bf16 v[80:95], v[220:223], v[188:191], v[80:95]
    v_exp_f32 v105, v73
    v_mfma_f32_32x32x16_bf16 v[80:95], v[224:227], v[204:207], v[80:95]
    s_waitcnt vmcnt(0)
    ds_read_b128 v[208:211], v238
    ds_read_b128 v[212:215], v239
    ds_read_b128 v[216:219], v240
    ds_read_b128 v[220:223], v241
    v_add_u32_sdwa v249, s74, v242 dst_sel:DWORD dst_unused:UNUSED_PAD src0_sel:WORD_0 src1_sel:DWORD
    ds_read_b128 v[224:227], v249
    s_bitcmp1_b32 s75, 5
    s_cbranch_scc0 NQR_t5
    s_and_b32 s81, s75, 0xfe00fe00
    v_add_u32_sdwa v250, s81, v244 dst_sel:DWORD dst_unused:UNUSED_PAD src0_sel:WORD_0 src1_sel:DWORD
    v_add_u32_sdwa v40, s81, v244 dst_sel:DWORD dst_unused:UNUSED_PAD src0_sel:WORD_1 src1_sel:DWORD
    ds_read2_b32 v[44:45], v250 offset0:0 offset1:32
    ds_read2_b32 v[48:49], v40 offset0:0 offset1:32
    ds_read2_b32 v[46:47], v250 offset0:64 offset1:96
    ds_read2_b32 v[50:51], v40 offset0:64 offset1:96
NQR_t5:
    v_pk_fma_f32 v[228:229], v[116:117], v[96:97], v[116:117]
    v_pk_fma_f32 v[116:117], v[64:65], v[124:125], v[228:229]
    v_pk_fma_f32 v[124:125], v[124:125], v[96:97], v[124:125]
    v_pk_fma_f32 v[228:229], v[116:117], v[98:99], v[116:117]
    v_pk_fma_f32 v[116:117], v[66:67], v[124:125], v[228:229]
    v_pk_fma_f32 v[124:125], v[124:125], v[98:99], v[124:125]
    v_pk_fma_f32 v[228:229], v[116:117], v[100:101], v[116:117]
    v_pk_fma_f32 v[116:117], v[68:69], v[124:125], v[228:229]
    v_pk_fma_f32 v[124:125], v[124:125], v[100:101], v[124:125]
    v_pk_fma_f32 v[228:229], v[116:117], v[102:103], v[116:117]
    v_pk_fma_f32 v[116:117], v[70:71], v[124:125], v[228:229]
    v_pk_fma_f32 v[124:125], v[124:125], v[102:103], v[124:125]
    v_pk_fma_f32 v[228:229], v[116:117], v[104:105], v[116:117]
    v_pk_fma_f32 v[116:117], v[72:73], v[124:125], v[228:229]
    v_pk_fma_f32 v[124:125], v[124:125], v[104:105], v[124:125]
    s_waitcnt lgkmcnt(0)
    s_bitcmp1_b32 s75, 5
    s_cbranch_scc0 NQM_t5
    v_perm_b32 v195, v48, v44, v41
    v_perm_b32 v199, v49, v45, v41
    v_perm_b32 v203, v50, v46, v41
    v_perm_b32 v207, v51, v47, v41
NQM_t5:
    v_mfma_f32_32x32x16_bf16 v[64:79], v[208:211], v[128:131], 0
    v_exp_f32 v96, v80
    v_exp_f32 v97, v81
    v_exp_f32 v98, v82
    v_mfma_f32_32x32x16_bf16 v[64:79], v[212:215], v[144:147], v[64:79]
    v_exp_f32 v99, v83
    v_exp_f32 v100, v84
    v_exp_f32 v101, v85
    v_mfma_f32_32x32x16_bf16 v[64:79], v[216:219], v[160:163], v[64:79]
    v_exp_f32 v102, v86
    v_exp_f32 v103, v87
    v_exp_f32 v104, v88
    v_mfma_f32_32x32x16_bf16 v[64:79], v[220:223], v[176:179], v[64:79]
    v_exp_f32 v105, v89
    v_mfma_f32_32x32x16_bf16 v[64:79], v[224:227], v[192:195], v[64:79]
    buffer_load_dwordx4 v[230:231], s[12:15], 0 idxen offen offset:0 lds
    buffer_load_dwordx4 v[232:233], s[12:15], 0 idxen offen offset:1024 lds
    buffer_load_dwordx4 v[234:235], s[12:15], 0 idxen offen offset:2048 lds
    buffer_load_dwordx4 v[236:237], s[12:15], 0 idxen offen offset:3072 lds
    v_pk_fma_f32 v[228:229], v[118:119], v[96:97], v[118:119]
    v_pk_fma_f32 v[118:119], v[80:81], v[126:127], v[228:229]
    v_pk_fma_f32 v[126:127], v[126:127], v[96:97], v[126:127]
    v_pk_fma_f32 v[228:229], v[118:119], v[98:99], v[118:119]
    v_pk_fma_f32 v[118:119], v[82:83], v[126:127], v[228:229]
    v_pk_fma_f32 v[126:127], v[126:127], v[98:99], v[126:127]
    v_pk_fma_f32 v[228:229], v[118:119], v[100:101], v[118:119]
    v_pk_fma_f32 v[118:119], v[84:85], v[126:127], v[228:229]
    v_pk_fma_f32 v[126:127], v[126:127], v[100:101], v[126:127]
    v_pk_fma_f32 v[228:229], v[118:119], v[102:103], v[118:119]
    v_pk_fma_f32 v[118:119], v[86:87], v[126:127], v[228:229]
    v_pk_fma_f32 v[126:127], v[126:127], v[102:103], v[126:127]
    v_pk_fma_f32 v[228:229], v[118:119], v[104:105], v[118:119]
    v_pk_fma_f32 v[118:119], v[88:89], v[126:127], v[228:229]
    v_pk_fma_f32 v[126:127], v[126:127], v[104:105], v[126:127]
    s_bitcmp1_b32 s73, 4
    s_cbranch_scc1 FLUSH
    s_mov_b64 s[72:73], s[74:75]
    s_mov_b64 s[74:75], s[76:77]
    v_readlane_b32 s76, v247, s101
    v_readlane_b32 s77, v245, s101
    s_add_u32 s101, s101, 1
    s_and_b32 s84, s73, 15
    s_mul_i32 s85, s84, s3
    s_add_u32 s90, s10, s85
    s_addc_u32 s91, s11, 0
    s_setpc_b64 s[90:91]
.p2align 11
TILE6:
    v_mfma_f32_32x32x16_bf16 v[80:95], v[208:211], v[132:135], 0
    v_exp_f32 v96, v64
    v_exp_f32 v97, v65
    v_exp_f32 v98, v66
    v_mfma_f32_32x32x16_bf16 v[80:95], v[212:215], v[148:151], v[80:95]
    v_exp_f32 v99, v67
    v_exp_f32 v100, v68
    v_exp_f32 v101, v69
    v_mfma_f32_32x32x16_bf16 v[80:95], v[216:219], v[164:167], v[80:95]
    v_exp_f32 v102, v70
    v_exp_f32 v103, v71
    v_exp_f32 v104, v72
    v_mfma_f32_32x32x16_bf16 v[80:95], v[220:223], v[180:183], v[80:95]
    v_exp_f32 v105, v73
    v_exp_f32 v106, v74
    v_exp_f32 v107, v75
    v_mfma_f32_32x32x16_bf16 v[80:95], v[224:227], v[196:199], v[80:95]
    s_nop 0
    v_pk_fma_f32 v[228:229], v[112:113], v[96:97], v[112:113]
    v_pk_fma_f32 v[112:113], v[64:65], v[120:121], v[228:229]
    v_pk_fma_f32 v[120:121], v[120:121], v[96:97], v[120:121]
    v_pk_fma_f32 v[228:229], v[112:113], v[98:99], v[112:113]
    v_pk_fma_f32 v[112:113], v[66:67], v[120:121], v[228:229]
    v_pk_fma_f32 v[120:121], v[120:121], v[98:99], v[120:121]
    v_pk_fma_f32 v[228:229], v[112:113], v[100:101], v[112:113]
    v_pk_fma_f32 v[112:113], v[68:69], v[120:121], v[228:229]
    v_pk_fma_f32 v[120:121], v[120:121], v[100:101], v[120:121]
    v_pk_fma_f32 v[228:229], v[112:113], v[102:103], v[112:113]
    v_pk_fma_f32 v[112:113], v[70:71], v[120:121], v[228:229]
    v_pk_fma_f32 v[120:121], v[120:121], v[102:103], v[120:121]
    v_pk_fma_f32 v[228:229], v[112:113], v[104:105], v[112:113]
    v_pk_fma_f32 v[112:113], v[72:73], v[120:121], v[228:229]
    v_pk_fma_f32 v[120:121], v[120:121], v[104:105], v[120:121]
    v_pk_fma_f32 v[228:229], v[112:113], v[106:107], v[112:113]
    v_pk_fma_f32 v[112:113], v[74:75], v[120:121], v[228:229]
    v_pk_fma_f32 v[120:121], v[120:121], v[106:107], v[120:121]
    v_mfma_f32_32x32x16_bf16 v[64:79], v[208:211], v[136:139], 0
    v_exp_f32 v96, v80
    v_exp_f32 v97, v81
    v_exp_f32 v98, v82
    v_mfma_f32_32x32x16_bf16 v[64:79], v[212:215], v[152:155], v[64:79]
    v_exp_f32 v99, v83
    v_exp_f32 v100, v84
    v_exp_f32 v101, v85
    v_mfma_f32_32x32x16_bf16 v[64:79], v[216:219], v[168:171], v[64:79]
    v_exp_f32 v102, v86
    v_exp_f32 v103, v87
    v_exp_f32 v104, v88
    v_mfma_f32_32x32x16_bf16 v[64:79], v[220:223], v[184:187], v[64:79]
    v_exp_f32 v105, v89
    v_exp_f32 v106, v90
    v_exp_f32 v107, v91
    v_mfma_f32_32x32x16_bf16 v[64:79], v[224:227], v[200:203], v[64:79]
    v_add_u32_sdwa v248, s76, v243 dst_sel:DWORD dst_unused:UNUSED_PAD src0_sel:WORD_0 src1_sel:DWORD
    ds_read_b32 v230, v248 offset:0
    ds_read_b32 v232, v248 offset:128
    ds_read_b32 v234, v248 offset:256
    ds_read_b32 v236, v248 offset:384
    v_pk_fma_f32 v[228:229], v[114:115], v[96:97], v[114:115]
    v_pk_fma_f32 v[114:115], v[80:81], v[122:123], v[228:229]
    v_pk_fma_f32 v[122:123], v[122:123], v[96:97], v[122:123]
    v_pk_fma_f32 v[228:229], v[114:115], v[98:99], v[114:115]
    v_pk_fma_f32 v[114:115], v[82:83], v[122:123], v[228:229]
    v_pk_fma_f32 v[122:123], v[122:123], v[98:99], v[122:123]
    v_pk_fma_f32 v[228:229], v[114:115], v[100:101], v[114:115]
    v_pk_fma_f32 v[114:115], v[84:85], v[122:123], v[228:229]
    v_pk_fma_f32 v[122:123], v[122:123], v[100:101], v[122:123]
    v_pk_fma_f32 v[228:229], v[114:115], v[102:103], v[114:115]
    v_pk_fma_f32 v[114:115], v[86:87], v[122:123], v[228:229]
    v_pk_fma_f32 v[122:123], v[122:123], v[102:103], v[122:123]
    v_pk_fma_f32 v[228:229], v[114:115], v[104:105], v[114:115]
    v_pk_fma_f32 v[114:115], v[88:89], v[122:123], v[228:229]
    v_pk_fma_f32 v[122:123], v[122:123], v[104:105], v[122:123]
    v_pk_fma_f32 v[228:229], v[114:115], v[106:107], v[114:115]
    v_pk_fma_f32 v[114:115], v[90:91], v[122:123], v[228:229]
    v_pk_fma_f32 v[122:123], v[122:123], v[106:107], v[122:123]
    v_mfma_f32_32x32x16_bf16 v[80:95], v[208:211], v[140:143], 0
    v_exp_f32 v96, v64
    v_exp_f32 v97, v65
    v_exp_f32 v98, v66
    v_mfma_f32_32x32x16_bf16 v[80:95], v[212:215], v[156:159], v[80:95]
    v_exp_f32 v99, v67
    v_exp_f32 v100, v68
    v_exp_f32 v101, v69
    v_mfma_f32_32x32x16_bf16 v[80:95], v[216:219], v[172:175], v[80:95]
    v_exp_f32 v102, v70
    v_exp_f32 v103, v71
    v_exp_f32 v104, v72
    v_mfma_f32_32x32x16_bf16 v[80:95], v[220:223], v[188:191], v[80:95]
    v_exp_f32 v105, v73
    v_exp_f32 v106, v74
    v_exp_f32 v107, v75
    v_mfma_f32_32x32x16_bf16 v[80:95], v[224:227], v[204:207], v[80:95]
    s_waitcnt vmcnt(0)
    ds_read_b128 v[208:211], v238
    ds_read_b128 v[212:215], v239
    ds_read_b128 v[216:219], v240
    ds_read_b128 v[220:223], v241
    v_add_u32_sdwa v249, s74, v242 dst_sel:DWORD dst_unused:UNUSED_PAD src0_sel:WORD_0 src1_sel:DWORD
    ds_read_b128 v[224:227], v249
    s_bitcmp1_b32 s75, 5
    s_cbranch_scc0 NQR_t6
    s_and_b32 s81, s75, 0xfe00fe00
    v_add_u32_sdwa v250, s81, v244 dst_sel:DWORD dst_unused:UNUSED_PAD src0_sel:WORD_0 src1_sel:DWORD
    v_add_u32_sdwa v40, s81, v244 dst_sel:DWORD dst_unused:UNUSED_PAD src0_sel:WORD_1 src1_sel:DWORD
    ds_read2_b32 v[44:45], v250 offset0:0 offset1:32
    ds_read2_b32 v[48:49], v40 offset0:0 offset1:32
    ds_read2_b32 v[46:47], v250 offset0:64 offset1:96
    ds_read2_b32 v[50:51], v40 offset0:64 offset1:96
NQR_t6:
    v_pk_fma_f32 v[228:229], v[116:117], v[96:97], v[116:117]
    v_pk_fma_f32 v[116:117], v[64:65], v[124:125], v[228:229]
    v_pk_fma_f32 v[124:125], v[124:125], v[96:97], v[124:125]
    v_pk_fma_f32 v[228:229], v[116:117], v[98:99], v[116:117]
    v_pk_fma_f32 v[116:117], v[66:67], v[124:125], v[228:229]
    v_pk_fma_f32 v[124:125], v[124:125], v[98:99], v[124:125]
    v_pk_fma_f32 v[228:229], v[116:117], v[100:101], v[116:117]
    v_pk_fma_f32 v[116:117], v[68:69], v[124:125], v[228:229]
    v_pk_fma_f32 v[124:125], v[124:125], v[100:101], v[124:125]
    v_pk_fma_f32 v[228:229], v[116:117], v[102:103], v[116:117]
    v_pk_fma_f32 v[116:117], v[70:71], v[124:125], v[228:229]
    v_pk_fma_f32 v[124:125], v[124:125], v[102:103], v[124:125]
    v_pk_fma_f32 v[228:229], v[116:117], v[104:105], v[116:117]
    v_pk_fma_f32 v[116:117], v[72:73], v[124:125], v[228:229]
    v_pk_fma_f32 v[124:125], v[124:125], v[104:105], v[124:125]
    v_pk_fma_f32 v[228:229], v[116:117], v[106:107], v[116:117]
    v_pk_fma_f32 v[116:117], v[74:75], v[124:125], v[228:229]
    v_pk_fma_f32 v[124:125], v[124:125], v[106:107], v[124:125]
    s_waitcnt lgkmcnt(0)
    s_bitcmp1_b32 s75, 5
    s_cbranch_scc0 NQM_t6
    v_perm_b32 v195, v48, v44, v41
    v_perm_b32 v199, v49, v45, v41
    v_perm_b32 v203, v50, v46, v41
    v_perm_b32 v207, v51, v47, v41
NQM_t6:
    v_mfma_f32_32x32x16_bf16 v[64:79], v[208:211], v[128:131], 0
    v_exp_f32 v96, v80
    v_exp_f32 v97, v81
    v_exp_f32 v98, v82
    v_mfma_f32_32x32x16_bf16 v[64:79], v[212:215], v[144:147], v[64:79]
    v_exp_f32 v99, v83
    v_exp_f32 v100, v84
    v_exp_f32 v101, v85
    v_mfma_f32_32x32x16_bf16 v[64:79], v[216:219], v[160:163], v[64:79]
    v_exp_f32 v102, v86
    v_exp_f32 v103, v87
    v_exp_f32 v104, v88
    v_mfma_f32_32x32x16_bf16 v[64:79], v[220:223], v[176:179], v[64:79]
    v_exp_f32 v105, v89
    v_exp_f32 v106, v90
    v_exp_f32 v107, v91
    v_mfma_f32_32x32x16_bf16 v[64:79], v[224:227], v[192:195], v[64:79]
    buffer_load_dwordx4 v[230:231], s[12:15], 0 idxen offen offset:0 lds
    buffer_load_dwordx4 v[232:233], s[12:15], 0 idxen offen offset:1024 lds
    buffer_load_dwordx4 v[234:235], s[12:15], 0 idxen offen offset:2048 lds
    buffer_load_dwordx4 v[236:237], s[12:15], 0 idxen offen offset:3072 lds
    v_pk_fma_f32 v[228:229], v[118:119], v[96:97], v[118:119]
    v_pk_fma_f32 v[118:119], v[80:81], v[126:127], v[228:229]
    v_pk_fma_f32 v[126:127], v[126:127], v[96:97], v[126:127]
    v_pk_fma_f32 v[228:229], v[118:119], v[98:99], v[118:119]
    v_pk_fma_f32 v[118:119], v[82:83], v[126:127], v[228:229]
    v_pk_fma_f32 v[126:127], v[126:127], v[98:99], v[126:127]
    v_pk_fma_f32 v[228:229], v[118:119], v[100:101], v[118:119]
    v_pk_fma_f32 v[118:119], v[84:85], v[126:127], v[228:229]
    v_pk_fma_f32 v[126:127], v[126:127], v[100:101], v[126:127]
    v_pk_fma_f32 v[228:229], v[118:119], v[102:103], v[118:119]
    v_pk_fma_f32 v[118:119], v[86:87], v[126:127], v[228:229]
    v_pk_fma_f32 v[126:127], v[126:127], v[102:103], v[126:127]
    v_pk_fma_f32 v[228:229], v[118:119], v[104:105], v[118:119]
    v_pk_fma_f32 v[118:119], v[88:89], v[126:127], v[228:229]
    v_pk_fma_f32 v[126:127], v[126:127], v[104:105], v[126:127]
    v_pk_fma_f32 v[228:229], v[118:119], v[106:107], v[118:119]
    v_pk_fma_f32 v[118:119], v[90:91], v[126:127], v[228:229]
    v_pk_fma_f32 v[126:127], v[126:127], v[106:107], v[126:127]
    s_bitcmp1_b32 s73, 4
    s_cbranch_scc1 FLUSH
    s_mov_b64 s[72:73], s[74:75]
    s_mov_b64 s[74:75], s[76:77]
    v_readlane_b32 s76, v247, s101
    v_readlane_b32 s77, v245, s101
    s_add_u32 s101, s101, 1
    s_and_b32 s84, s73, 15
    s_mul_i32 s85, s84, s3
    s_add_u32 s90, s10, s85
    s_addc_u32 s91, s11, 0
    s_setpc_b64 s[90:91]
.p2align 11
TILE7:
    v_mfma_f32_32x32x16_bf16 v[80:95], v[208:211], v[132:135], 0
    v_exp_f32 v96, v64
    v_exp_f32 v97, v65
    v_exp_f32 v98, v66
    v_mfma_f32_32x32x16_bf16 v[80:95], v[212:215], v[148:151], v[80:95]
    v_exp_f32 v99, v67
    v_exp_f32 v100, v68
    v_exp_f32 v101, v69
    v_mfma_f32_32x32x16_bf16 v[80:95], v[216:219], v[164:167], v[80:95]
    v_exp_f32 v102, v70
    v_exp_f32 v103, v71
    v_exp_f32 v104, v72
    v_mfma_f32_32x32x16_bf16 v[80:95], v[220:223], v[180:183], v[80:95]
    v_exp_f32 v105, v73
    v_exp_f32 v106, v74
    v_exp_f32 v107, v75
    v_mfma_f32_32x32x16_bf16 v[80:95], v[224:227], v[196:199], v[80:95]
    v_exp_f32 v108, v76
    v_exp_f32 v109, v77
    v_pk_fma_f32 v[228:229], v[112:113], v[96:97], v[112:113]
    v_pk_fma_f32 v[112:113], v[64:65], v[120:121], v[228:229]
    v_pk_fma_f32 v[120:121], v[120:121], v[96:97], v[120:121]
    v_pk_fma_f32 v[228:229], v[112:113], v[98:99], v[112:113]
    v_pk_fma_f32 v[112:113], v[66:67], v[120:121], v[228:229]
    v_pk_fma_f32 v[120:121], v[120:121], v[98:99], v[120:121]
    v_pk_fma_f32 v[228:229], v[112:113], v[100:101], v[112:113]
    v_pk_fma_f32 v[112:113], v[68:69], v[120:121], v[228:229]
    v_pk_fma_f32 v[120:121], v[120:121], v[100:101], v[120:121]
    v_pk_fma_f32 v[228:229], v[112:113], v[102:103], v[112:113]
    v_pk_fma_f32 v[112:113], v[70:71], v[120:121], v[228:229]
    v_pk_fma_f32 v[120:121], v[120:121], v[102:103], v[120:121]
    v_pk_fma_f32 v[228:229], v[112:113], v[104:105], v[112:113]
    v_pk_fma_f32 v[112:113], v[72:73], v[120:121], v[228:229]
    v_pk_fma_f32 v[120:121], v[120:121], v[104:105], v[120:121]
    v_pk_fma_f32 v[228:229], v[112:113], v[106:107], v[112:113]
    v_pk_fma_f32 v[112:113], v[74:75], v[120:121], v[228:229]
    v_pk_fma_f32 v[120:121], v[120:121], v[106:107], v[120:121]
    v_pk_fma_f32 v[228:229], v[112:113], v[108:109], v[112:113]
    v_pk_fma_f32 v[112:113], v[76:77], v[120:121], v[228:229]
    v_pk_fma_f32 v[120:121], v[120:121], v[108:109], v[120:121]
    v_mfma_f32_32x32x16_bf16 v[64:79], v[208:211], v[136:139], 0
    v_exp_f32 v96, v80
    v_exp_f32 v97, v81
    v_exp_f32 v98, v82
    v_mfma_f32_32x32x16_bf16 v[64:79], v[212:215], v[152:155], v[64:79]
    v_exp_f32 v99, v83
    v_exp_f32 v100, v84
    v_exp_f32 v101, v85
    v_mfma_f32_32x32x16_bf16 v[64:79], v[216:219], v[168:171], v[64:79]
    v_exp_f32 v102, v86
    v_exp_f32 v103, v87
    v_exp_f32 v104, v88
    v_mfma_f32_32x32x16_bf16 v[64:79], v[220:223], v[184:187], v[64:79]
    v_exp_f32 v105, v89
    v_exp_f32 v106, v90
    v_exp_f32 v107, v91
    v_mfma_f32_32x32x16_bf16 v[64:79], v[224:227], v[200:203], v[64:79]
    v_exp_f32 v108, v92
    v_exp_f32 v109, v93
    v_add_u32_sdwa v248, s76, v243 dst_sel:DWORD dst_unused:UNUSED_PAD src0_sel:WORD_0 src1_sel:DWORD
    ds_read_b32 v230, v248 offset:0
    ds_read_b32 v232, v248 offset:128
    ds_read_b32 v234, v248 offset:256
    ds_read_b32 v236, v248 offset:384
    v_pk_fma_f32 v[228:229], v[114:115], v[96:97], v[114:115]
    v_pk_fma_f32 v[114:115], v[80:81], v[122:123], v[228:229]
    v_pk_fma_f32 v[122:123], v[122:123], v[96:97], v[122:123]
    v_pk_fma_f32 v[228:229], v[114:115], v[98:99], v[114:115]
    v_pk_fma_f32 v[114:115], v[82:83], v[122:123], v[228:229]
    v_pk_fma_f32 v[122:123], v[122:123], v[98:99], v[122:123]
    v_pk_fma_f32 v[228:229], v[114:115], v[100:101], v[114:115]
    v_pk_fma_f32 v[114:115], v[84:85], v[122:123], v[228:229]
    v_pk_fma_f32 v[122:123], v[122:123], v[100:101], v[122:123]
    v_pk_fma_f32 v[228:229], v[114:115], v[102:103], v[114:115]
    v_pk_fma_f32 v[114:115], v[86:87], v[122:123], v[228:229]
    v_pk_fma_f32 v[122:123], v[122:123], v[102:103], v[122:123]
    v_pk_fma_f32 v[228:229], v[114:115], v[104:105], v[114:115]
    v_pk_fma_f32 v[114:115], v[88:89], v[122:123], v[228:229]
    v_pk_fma_f32 v[122:123], v[122:123], v[104:105], v[122:123]
    v_pk_fma_f32 v[228:229], v[114:115], v[106:107], v[114:115]
    v_pk_fma_f32 v[114:115], v[90:91], v[122:123], v[228:229]
    v_pk_fma_f32 v[122:123], v[122:123], v[106:107], v[122:123]
    v_pk_fma_f32 v[228:229], v[114:115], v[108:109], v[114:115]
    v_pk_fma_f32 v[114:115], v[92:93], v[122:123], v[228:229]
    v_pk_fma_f32 v[122:123], v[122:123], v[108:109], v[122:123]
    v_mfma_f32_32x32x16_bf16 v[80:95], v[208:211], v[140:143], 0
    v_exp_f32 v96, v64
    v_exp_f32 v97, v65
    v_exp_f32 v98, v66
    v_mfma_f32_32x32x16_bf16 v[80:95], v[212:215], v[156:159], v[80:95]
    v_exp_f32 v99, v67
    v_exp_f32 v100, v68
    v_exp_f32 v101, v69
    v_mfma_f32_32x32x16_bf16 v[80:95], v[216:219], v[172:175], v[80:95]
    v_exp_f32 v102, v70
    v_exp_f32 v103, v71
    v_exp_f32 v104, v72
    v_mfma_f32_32x32x16_bf16 v[80:95], v[220:223], v[188:191], v[80:95]
    v_exp_f32 v105, v73
    v_exp_f32 v106, v74
    v_exp_f32 v107, v75
    v_mfma_f32_32x32x16_bf16 v[80:95], v[224:227], v[204:207], v[80:95]
    v_exp_f32 v108, v76
    v_exp_f32 v109, v77
    s_waitcnt vmcnt(0)
    ds_read_b128 v[208:211], v238
    ds_read_b128 v[212:215], v239
    ds_read_b128 v[216:219], v240
    ds_read_b128 v[220:223], v241
    v_add_u32_sdwa v249, s74, v242 dst_sel:DWORD dst_unused:UNUSED_PAD src0_sel:WORD_0 src1_sel:DWORD
    ds_read_b128 v[224:227], v249
    s_bitcmp1_b32 s75, 5
    s_cbranch_scc0 NQR_t7
    s_and_b32 s81, s75, 0xfe00fe00
    v_add_u32_sdwa v250, s81, v244 dst_sel:DWORD dst_unused:UNUSED_PAD src0_sel:WORD_0 src1_sel:DWORD
    v_add_u32_sdwa v40, s81, v244 dst_sel:DWORD dst_unused:UNUSED_PAD src0_sel:WORD_1 src1_sel:DWORD
    ds_read2_b32 v[44:45], v250 offset0:0 offset1:32
    ds_read2_b32 v[48:49], v40 offset0:0 offset1:32
    ds_read2_b32 v[46:47], v250 offset0:64 offset1:96
    ds_read2_b32 v[50:51], v40 offset0:64 offset1:96
NQR_t7:
    v_pk_fma_f32 v[228:229], v[116:117], v[96:97], v[116:117]
    v_pk_fma_f32 v[116:117], v[64:65], v[124:125], v[228:229]
    v_pk_fma_f32 v[124:125], v[124:125], v[96:97], v[124:125]
    v_pk_fma_f32 v[228:229], v[116:117], v[98:99], v[116:117]
    v_pk_fma_f32 v[116:117], v[66:67], v[124:125], v[228:229]
    v_pk_fma_f32 v[124:125], v[124:125], v[98:99], v[124:125]
    v_pk_fma_f32 v[228:229], v[116:117], v[100:101], v[116:117]
    v_pk_fma_f32 v[116:117], v[68:69], v[124:125], v[228:229]
    v_pk_fma_f32 v[124:125], v[124:125], v[100:101], v[124:125]
    v_pk_fma_f32 v[228:229], v[116:117], v[102:103], v[116:117]
    v_pk_fma_f32 v[116:117], v[70:71], v[124:125], v[228:229]
    v_pk_fma_f32 v[124:125], v[124:125], v[102:103], v[124:125]
    v_pk_fma_f32 v[228:229], v[116:117], v[104:105], v[116:117]
    v_pk_fma_f32 v[116:117], v[72:73], v[124:125], v[228:229]
    v_pk_fma_f32 v[124:125], v[124:125], v[104:105], v[124:125]
    v_pk_fma_f32 v[228:229], v[116:117], v[106:107], v[116:117]
    v_pk_fma_f32 v[116:117], v[74:75], v[124:125], v[228:229]
    v_pk_fma_f32 v[124:125], v[124:125], v[106:107], v[124:125]
    v_pk_fma_f32 v[228:229], v[116:117], v[108:109], v[116:117]
    v_pk_fma_f32 v[116:117], v[76:77], v[124:125], v[228:229]
    v_pk_fma_f32 v[124:125], v[124:125], v[108:109], v[124:125]
    s_waitcnt lgkmcnt(0)
    s_bitcmp1_b32 s75, 5
    s_cbranch_scc0 NQM_t7
    v_perm_b32 v195, v48, v44, v41
    v_perm_b32 v199, v49, v45, v41
    v_perm_b32 v203, v50, v46, v41
    v_perm_b32 v207, v51, v47, v41
NQM_t7:
    v_mfma_f32_32x32x16_bf16 v[64:79], v[208:211], v[128:131], 0
    v_exp_f32 v96, v80
    v_exp_f32 v97, v81
    v_exp_f32 v98, v82
    v_mfma_f32_32x32x16_bf16 v[64:79], v[212:215], v[144:147], v[64:79]
    v_exp_f32 v99, v83
    v_exp_f32 v100, v84
    v_exp_f32 v101, v85
    v_mfma_f32_32x32x16_bf16 v[64:79], v[216:219], v[160:163], v[64:79]
    v_exp_f32 v102, v86
    v_exp_f32 v103, v87
    v_exp_f32 v104, v88
    v_mfma_f32_32x32x16_bf16 v[64:79], v[220:223], v[176:179], v[64:79]
    v_exp_f32 v105, v89
    v_exp_f32 v106, v90
    v_exp_f32 v107, v91
    v_mfma_f32_32x32x16_bf16 v[64:79], v[224:227], v[192:195], v[64:79]
    v_exp_f32 v108, v92
    v_exp_f32 v109, v93
    buffer_load_dwordx4 v[230:231], s[12:15], 0 idxen offen offset:0 lds
    buffer_load_dwordx4 v[232:233], s[12:15], 0 idxen offen offset:1024 lds
    buffer_load_dwordx4 v[234:235], s[12:15], 0 idxen offen offset:2048 lds
    buffer_load_dwordx4 v[236:237], s[12:15], 0 idxen offen offset:3072 lds
    v_pk_fma_f32 v[228:229], v[118:119], v[96:97], v[118:119]
    v_pk_fma_f32 v[118:119], v[80:81], v[126:127], v[228:229]
    v_pk_fma_f32 v[126:127], v[126:127], v[96:97], v[126:127]
    v_pk_fma_f32 v[228:229], v[118:119], v[98:99], v[118:119]
    v_pk_fma_f32 v[118:119], v[82:83], v[126:127], v[228:229]
    v_pk_fma_f32 v[126:127], v[126:127], v[98:99], v[126:127]
    v_pk_fma_f32 v[228:229], v[118:119], v[100:101], v[118:119]
    v_pk_fma_f32 v[118:119], v[84:85], v[126:127], v[228:229]
    v_pk_fma_f32 v[126:127], v[126:127], v[100:101], v[126:127]
    v_pk_fma_f32 v[228:229], v[118:119], v[102:103], v[118:119]
    v_pk_fma_f32 v[118:119], v[86:87], v[126:127], v[228:229]
    v_pk_fma_f32 v[126:127], v[126:127], v[102:103], v[126:127]
    v_pk_fma_f32 v[228:229], v[118:119], v[104:105], v[118:119]
    v_pk_fma_f32 v[118:119], v[88:89], v[126:127], v[228:229]
    v_pk_fma_f32 v[126:127], v[126:127], v[104:105], v[126:127]
    v_pk_fma_f32 v[228:229], v[118:119], v[106:107], v[118:119]
    v_pk_fma_f32 v[118:119], v[90:91], v[126:127], v[228:229]
    v_pk_fma_f32 v[126:127], v[126:127], v[106:107], v[126:127]
    v_pk_fma_f32 v[228:229], v[118:119], v[108:109], v[118:119]
    v_pk_fma_f32 v[118:119], v[92:93], v[126:127], v[228:229]
    v_pk_fma_f32 v[126:127], v[126:127], v[108:109], v[126:127]
    s_bitcmp1_b32 s73, 4
    s_cbranch_scc1 FLUSH
    s_mov_b64 s[72:73], s[74:75]
    s_mov_b64 s[74:75], s[76:77]
    v_readlane_b32 s76, v247, s101
    v_readlane_b32 s77, v245, s101
    s_add_u32 s101, s101, 1
    s_and_b32 s84, s73, 15
    s_mul_i32 s85, s84, s3
    s_add_u32 s90, s10, s85
    s_addc_u32 s91, s11, 0
    s_setpc_b64 s[90:91]
.p2align 11
TILE8:
    v_mfma_f32_32x32x16_bf16 v[80:95], v[208:211], v[132:135], 0
    v_exp_f32 v96, v64
    v_exp_f32 v97, v65
    v_exp_f32 v98, v66
    v_mfma_f32_32x32x16_bf16 v[80:95], v[212:215], v[148:151], v[80:95]
    v_exp_f32 v99, v67
    v_exp_f32 v100, v68
    v_exp_f32 v101, v69
    v_mfma_f32_32x32x16_bf16 v[80:95], v[216:219], v[164:167], v[80:95]
    v_exp_f32 v102, v70
    v_exp_f32 v103, v71
    v_exp_f32 v104, v72
    v_mfma_f32_32x32x16_bf16 v[80:95], v[220:223], v[180:183], v[80:95]
    v_exp_f32 v105, v73
    v_exp_f32 v106, v74
    v_exp_f32 v107, v75
    v_mfma_f32_32x32x16_bf16 v[80:95], v[224:227], v[196:199], v[80:95]
    v_exp_f32 v108, v76
    v_exp_f32 v109, v77
    v_exp_f32 v110, v78
    v_exp_f32 v111, v79
    v_pk_fma_f32 v[228:229], v[112:113], v[96:97], v[112:113]
    v_pk_fma_f32 v[112:113], v[64:65], v[120:121], v[228:229]
    v_pk_fma_f32 v[120:121], v[120:121], v[96:97], v[120:121]
    v_pk_fma_f32 v[228:229], v[112:113], v[98:99], v[112:113]
    v_pk_fma_f32 v[112:113], v[66:67], v[120:121], v[228:229]
    v_pk_fma_f32 v[120:121], v[120:121], v[98:99], v[120:121]
    v_pk_fma_f32 v[228:229], v[112:113], v[100:101], v[112:113]
    v_pk_fma_f32 v[112:113], v[68:69], v[120:121], v[228:229]
    v_pk_fma_f32 v[120:121], v[120:121], v[100:101], v[120:121]
    v_pk_fma_f32 v[228:229], v[112:113], v[102:103], v[112:113]
    v_pk_fma_f32 v[112:113], v[70:71], v[120:121], v[228:229]
    v_pk_fma_f32 v[120:121], v[120:121], v[102:103], v[120:121]
    v_pk_fma_f32 v[228:229], v[112:113], v[104:105], v[112:113]
    v_pk_fma_f32 v[112:113], v[72:73], v[120:121], v[228:229]
    v_pk_fma_f32 v[120:121], v[120:121], v[104:105], v[120:121]
    v_pk_fma_f32 v[228:229], v[112:113], v[106:107], v[112:113]
    v_pk_fma_f32 v[112:113], v[74:75], v[120:121], v[228:229]
    v_pk_fma_f32 v[120:121], v[120:121], v[106:107], v[120:121]
    v_pk_fma_f32 v[228:229], v[112:113], v[108:109], v[112:113]
    v_pk_fma_f32 v[112:113], v[76:77], v[120:121], v[228:229]
    v_pk_fma_f32 v[120:121], v[120:121], v[108:109], v[120:121]
    v_pk_fma_f32 v[228:229], v[112:113], v[110:111], v[112:113]
    v_pk_fma_f32 v[112:113], v[78:79], v[120:121], v[228:229]
    v_pk_fma_f32 v[120:121], v[120:121], v[110:111], v[120:121]
    v_mfma_f32_32x32x16_bf16 v[64:79], v[208:211], v[136:139], 0
    v_exp_f32 v96, v80
    v_exp_f32 v97, v81
    v_exp_f32 v98, v82
    v_mfma_f32_32x32x16_bf16 v[64:79], v[212:215], v[152:155], v[64:79]
    v_exp_f32 v99, v83
    v_exp_f32 v100, v84
    v_exp_f32 v101, v85
    v_mfma_f32_32x32x16_bf16 v[64:79], v[216:219], v[168:171], v[64:79]
    v_exp_f32 v102, v86
    v_exp_f32 v103, v87
    v_exp_f32 v104, v88
    v_mfma_f32_32x32x16_bf16 v[64:79], v[220:223], v[184:187], v[64:79]
    v_exp_f32 v105, v89
    v_exp_f32 v106, v90
    v_exp_f32 v107, v91
    v_mfma_f32_32x32x16_bf16 v[64:79], v[224:227], v[200:203], v[64:79]
    v_exp_f32 v108, v92
    v_exp_f32 v109, v93
    v_exp_f32 v110, v94
    v_exp_f32 v111, v95
    v_add_u32_sdwa v248, s76, v243 dst_sel:DWORD dst_unused:UNUSED_PAD src0_sel:WORD_0 src1_sel:DWORD
    ds_read_b32 v230, v248 offset:0
    ds_read_b32 v232, v248 offset:128
    ds_read_b32 v234, v248 offset:256
    ds_read_b32 v236, v248 offset:384
    v_pk_fma_f32 v[228:229], v[114:115], v[96:97], v[114:115]
    v_pk_fma_f32 v[114:115], v[80:81], v[122:123], v[228:229]
    v_pk_fma_f32 v[122:123], v[122:123], v[96:97], v[122:123]
    v_pk_fma_f32 v[228:229], v[114:115], v[98:99], v[114:115]
    v_pk_fma_f32 v[114:115], v[82:83], v[122:123], v[228:229]
    v_pk_fma_f32 v[122:123], v[122:123], v[98:99], v[122:123]
    v_pk_fma_f32 v[228:229], v[114:115], v[100:101], v[114:115]
    v_pk_fma_f32 v[114:115], v[84:85], v[122:123], v[228:229]
    v_pk_fma_f32 v[122:123], v[122:123], v[100:101], v[122:123]
    v_pk_fma_f32 v[228:229], v[114:115], v[102:103], v[114:115]
    v_pk_fma_f32 v[114:115], v[86:87], v[122:123], v[228:229]
    v_pk_fma_f32 v[122:123], v[122:123], v[102:103], v[122:123]
    v_pk_fma_f32 v[228:229], v[114:115], v[104:105], v[114:115]
    v_pk_fma_f32 v[114:115], v[88:89], v[122:123], v[228:229]
    v_pk_fma_f32 v[122:123], v[122:123], v[104:105], v[122:123]
    v_pk_fma_f32 v[228:229], v[114:115], v[106:107], v[114:115]
    v_pk_fma_f32 v[114:115], v[90:91], v[122:123], v[228:229]
    v_pk_fma_f32 v[122:123], v[122:123], v[106:107], v[122:123]
    v_pk_fma_f32 v[228:229], v[114:115], v[108:109], v[114:115]
    v_pk_fma_f32 v[114:115], v[92:93], v[122:123], v[228:229]
    v_pk_fma_f32 v[122:123], v[122:123], v[108:109], v[122:123]
    v_pk_fma_f32 v[228:229], v[114:115], v[110:111], v[114:115]
    v_pk_fma_f32 v[114:115], v[94:95], v[122:123], v[228:229]
    v_pk_fma_f32 v[122:123], v[122:123], v[110:111], v[122:123]
    v_mfma_f32_32x32x16_bf16 v[80:95], v[208:211], v[140:143], 0
    v_exp_f32 v96, v64
    v_exp_f32 v97, v65
    v_exp_f32 v98, v66
    v_mfma_f32_32x32x16_bf16 v[80:95], v[212:215], v[156:159], v[80:95]
    v_exp_f32 v99, v67
    v_exp_f32 v100, v68
    v_exp_f32 v101, v69
    v_mfma_f32_32x32x16_bf16 v[80:95], v[216:219], v[172:175], v[80:95]
    v_exp_f32 v102, v70
    v_exp_f32 v103, v71
    v_exp_f32 v104, v72
    v_mfma_f32_32x32x16_bf16 v[80:95], v[220:223], v[188:191], v[80:95]
    v_exp_f32 v105, v73
    v_exp_f32 v106, v74
    v_exp_f32 v107, v75
    v_mfma_f32_32x32x16_bf16 v[80:95], v[224:227], v[204:207], v[80:95]
    v_exp_f32 v108, v76
    v_exp_f32 v109, v77
    v_exp_f32 v110, v78
    v_exp_f32 v111, v79
    s_waitcnt vmcnt(0)
    ds_read_b128 v[208:211], v238
    ds_read_b128 v[212:215], v239
    ds_read_b128 v[216:219], v240
    ds_read_b128 v[220:223], v241
    v_add_u32_sdwa v249, s74, v242 dst_sel:DWORD dst_unused:UNUSED_PAD src0_sel:WORD_0 src1_sel:DWORD
    ds_read_b128 v[224:227], v249
    s_bitcmp1_b32 s75, 5
    s_cbranch_scc0 NQR_t8
    s_and_b32 s81, s75, 0xfe00fe00
    v_add_u32_sdwa v250, s81, v244 dst_sel:DWORD dst_unused:UNUSED_PAD src0_sel:WORD_0 src1_sel:DWORD
    v_add_u32_sdwa v40, s81, v244 dst_sel:DWORD dst_unused:UNUSED_PAD src0_sel:WORD_1 src1_sel:DWORD
    ds_read2_b32 v[44:45], v250 offset0:0 offset1:32
    ds_read2_b32 v[48:49], v40 offset0:0 offset1:32
    ds_read2_b32 v[46:47], v250 offset0:64 offset1:96
    ds_read2_b32 v[50:51], v40 offset0:64 offset1:96
NQR_t8:
    v_pk_fma_f32 v[228:229], v[116:117], v[96:97], v[116:117]
    v_pk_fma_f32 v[116:117], v[64:65], v[124:125], v[228:229]
    v_pk_fma_f32 v[124:125], v[124:125], v[96:97], v[124:125]
    v_pk_fma_f32 v[228:229], v[116:117], v[98:99], v[116:117]
    v_pk_fma_f32 v[116:117], v[66:67], v[124:125], v[228:229]
    v_pk_fma_f32 v[124:125], v[124:125], v[98:99], v[124:125]
    v_pk_fma_f32 v[228:229], v[116:117], v[100:101], v[116:117]
    v_pk_fma_f32 v[116:117], v[68:69], v[124:125], v[228:229]
    v_pk_fma_f32 v[124:125], v[124:125], v[100:101], v[124:125]
    v_pk_fma_f32 v[228:229], v[116:117], v[102:103], v[116:117]
    v_pk_fma_f32 v[116:117], v[70:71], v[124:125], v[228:229]
    v_pk_fma_f32 v[124:125], v[124:125], v[102:103], v[124:125]
    v_pk_fma_f32 v[228:229], v[116:117], v[104:105], v[116:117]
    v_pk_fma_f32 v[116:117], v[72:73], v[124:125], v[228:229]
    v_pk_fma_f32 v[124:125], v[124:125], v[104:105], v[124:125]
    v_pk_fma_f32 v[228:229], v[116:117], v[106:107], v[116:117]
    v_pk_fma_f32 v[116:117], v[74:75], v[124:125], v[228:229]
    v_pk_fma_f32 v[124:125], v[124:125], v[106:107], v[124:125]
    v_pk_fma_f32 v[228:229], v[116:117], v[108:109], v[116:117]
    v_pk_fma_f32 v[116:117], v[76:77], v[124:125], v[228:229]
    v_pk_fma_f32 v[124:125], v[124:125], v[108:109], v[124:125]
    v_pk_fma_f32 v[228:229], v[116:117], v[110:111], v[116:117]
    v_pk_fma_f32 v[116:117], v[78:79], v[124:125], v[228:229]
    v_pk_fma_f32 v[124:125], v[124:125], v[110:111], v[124:125]
    s_waitcnt lgkmcnt(0)
    s_bitcmp1_b32 s75, 5
    s_cbranch_scc0 NQM_t8
    v_perm_b32 v195, v48, v44, v41
    v_perm_b32 v199, v49, v45, v41
    v_perm_b32 v203, v50, v46, v41
    v_perm_b32 v207, v51, v47, v41
NQM_t8:
    v_mfma_f32_32x32x16_bf16 v[64:79], v[208:211], v[128:131], 0
    v_exp_f32 v96, v80
    v_exp_f32 v97, v81
    v_exp_f32 v98, v82
    v_mfma_f32_32x32x16_bf16 v[64:79], v[212:215], v[144:147], v[64:79]
    v_exp_f32 v99, v83
    v_exp_f32 v100, v84
    v_exp_f32 v101, v85
    v_mfma_f32_32x32x16_bf16 v[64:79], v[216:219], v[160:163], v[64:79]
    v_exp_f32 v102, v86
    v_exp_f32 v103, v87
    v_exp_f32 v104, v88
    v_mfma_f32_32x32x16_bf16 v[64:79], v[220:223], v[176:179], v[64:79]
    v_exp_f32 v105, v89
    v_exp_f32 v106, v90
    v_exp_f32 v107, v91
    v_mfma_f32_32x32x16_bf16 v[64:79], v[224:227], v[192:195], v[64:79]
    v_exp_f32 v108, v92
    v_exp_f32 v109, v93
    v_exp_f32 v110, v94
    v_exp_f32 v111, v95
    buffer_load_dwordx4 v[230:231], s[12:15], 0 idxen offen offset:0 lds
    buffer_load_dwordx4 v[232:233], s[12:15], 0 idxen offen offset:1024 lds
    buffer_load_dwordx4 v[234:235], s[12:15], 0 idxen offen offset:2048 lds
    buffer_load_dwordx4 v[236:237], s[12:15], 0 idxen offen offset:3072 lds
    v_pk_fma_f32 v[228:229], v[118:119], v[96:97], v[118:119]
    v_pk_fma_f32 v[118:119], v[80:81], v[126:127], v[228:229]
    v_pk_fma_f32 v[126:127], v[126:127], v[96:97], v[126:127]
    v_pk_fma_f32 v[228:229], v[118:119], v[98:99], v[118:119]
    v_pk_fma_f32 v[118:119], v[82:83], v[126:127], v[228:229]
    v_pk_fma_f32 v[126:127], v[126:127], v[98:99], v[126:127]
    v_pk_fma_f32 v[228:229], v[118:119], v[100:101], v[118:119]
    v_pk_fma_f32 v[118:119], v[84:85], v[126:127], v[228:229]
    v_pk_fma_f32 v[126:127], v[126:127], v[100:101], v[126:127]
    v_pk_fma_f32 v[228:229], v[118:119], v[102:103], v[118:119]
    v_pk_fma_f32 v[118:119], v[86:87], v[126:127], v[228:229]
    v_pk_fma_f32 v[126:127], v[126:127], v[102:103], v[126:127]
    v_pk_fma_f32 v[228:229], v[118:119], v[104:105], v[118:119]
    v_pk_fma_f32 v[118:119], v[88:89], v[126:127], v[228:229]
    v_pk_fma_f32 v[126:127], v[126:127], v[104:105], v[126:127]
    v_pk_fma_f32 v[228:229], v[118:119], v[106:107], v[118:119]
    v_pk_fma_f32 v[118:119], v[90:91], v[126:127], v[228:229]
    v_pk_fma_f32 v[126:127], v[126:127], v[106:107], v[126:127]
    v_pk_fma_f32 v[228:229], v[118:119], v[108:109], v[118:119]
    v_pk_fma_f32 v[118:119], v[92:93], v[126:127], v[228:229]
    v_pk_fma_f32 v[126:127], v[126:127], v[108:109], v[126:127]
    v_pk_fma_f32 v[228:229], v[118:119], v[110:111], v[118:119]
    v_pk_fma_f32 v[118:119], v[94:95], v[126:127], v[228:229]
    v_pk_fma_f32 v[126:127], v[126:127], v[110:111], v[126:127]
    s_bitcmp1_b32 s73, 4
    s_cbranch_scc1 FLUSH
    s_mov_b64 s[72:73], s[74:75]
    s_mov_b64 s[74:75], s[76:77]
    v_readlane_b32 s76, v247, s101
    v_readlane_b32 s77, v245, s101
    s_add_u32 s101, s101, 1
    s_and_b32 s84, s73, 15
    s_mul_i32 s85, s84, s3
    s_add_u32 s90, s10, s85
    s_addc_u32 s91, s11, 0
    s_setpc_b64 s[90:91]
.p2align 11
BT1:
    v_mfma_f32_32x32x16_bf16 v[80:95], v[208:211], v[132:135], 0
    v_exp_f32 v96, v64
    v_exp_f32 v97, v65
    v_exp_f32 v98, v66
    v_mfma_f32_32x32x16_bf16 v[80:95], v[212:215], v[148:151], v[80:95]
    v_exp_f32 v99, v67
    v_exp_f32 v100, v68
    v_exp_f32 v101, v69
    v_mfma_f32_32x32x16_bf16 v[80:95], v[216:219], v[164:167], v[80:95]
    v_exp_f32 v102, v70
    v_exp_f32 v103, v71
    v_exp_f32 v104, v72
    v_mfma_f32_32x32x16_bf16 v[80:95], v[220:223], v[180:183], v[80:95]
    v_exp_f32 v105, v73
    v_exp_f32 v106, v74
    v_exp_f32 v107, v75
    v_mfma_f32_32x32x16_bf16 v[80:95], v[224:227], v[196:199], v[80:95]
    v_exp_f32 v108, v76
    v_exp_f32 v109, v77
    v_exp_f32 v110, v78
    v_exp_f32 v111, v79
    v_pk_fma_f32 v[228:229], v[112:113], v[96:97], v[112:113]
    v_pk_fma_f32 v[112:113], v[64:65], v[120:121], v[228:229]
    v_pk_fma_f32 v[120:121], v[120:121], v[96:97], v[120:121]
    v_rcp_f32 v36, v120
    v_rcp_f32 v37, v121
    v_pk_mul_f32 v[38:39], v[120:121], 0 op_sel_hi:[1,0]
    v_pk_fma_f32 v[38:39], v[112:113], v[36:37], v[38:39]
    v_pk_add_f32 v[120:121], v[98:99], 1.0 op_sel_hi:[1,0]
    v_add_f32 v32, v38, v39
    v_pk_fma_f32 v[228:229], v[66:67], v[100:101], v[66:67]
    v_pk_fma_f32 v[112:113], v[68:69], v[120:121], v[228:229]
    v_pk_fma_f32 v[120:121], v[120:121], v[100:101], v[120:121]
    v_pk_fma_f32 v[228:229], v[112:113], v[102:103], v[112:113]
    v_pk_fma_f32 v[112:113], v[70:71], v[120:121], v[228:229]
    v_pk_fma_f32 v[120:121], v[120:121], v[102:103], v[120:121]
    v_pk_fma_f32 v[228:229], v[112:113], v[104:105], v[112:113]
    v_pk_fma_f32 v[112:113], v[72:73], v[120:121], v[228:229]
    v_pk_fma_f32 v[120:121], v[120:121], v[104:105], v[120:121]
    v_pk_fma_f32 v[228:229], v[112:113], v[106:107], v[112:113]
    v_pk_fma_f32 v[112:113], v[74:75], v[120:121], v[228:229]
    v_pk_fma_f32 v[120:121], v[120:121], v[106:107], v[120:121]
    v_pk_fma_f32 v[228:229], v[112:113], v[108:109], v[112:113]
    v_pk_fma_f32 v[112:113], v[76:77], v[120:121], v[228:229]
    v_pk_fma_f32 v[120:121], v[120:121], v[108:109], v[120:121]
    v_pk_fma_f32 v[228:229], v[112:113], v[110:111], v[112:113]
    v_pk_fma_f32 v[112:113], v[78:79], v[120:121], v[228:229]
    v_pk_fma_f32 v[120:121], v[120:121], v[110:111], v[120:121]
    v_mfma_f32_32x32x16_bf16 v[64:79], v[208:211], v[136:139], 0
    v_exp_f32 v96, v80
    v_exp_f32 v97, v81
    v_exp_f32 v98, v82
    v_mfma_f32_32x32x16_bf16 v[64:79], v[212:215], v[152:155], v[64:79]
    v_exp_f32 v99, v83
    v_exp_f32 v100, v84
    v_exp_f32 v101, v85
    v_mfma_f32_32x32x16_bf16 v[64:79], v[216:219], v[168:171], v[64:79]
    v_exp_f32 v102, v86
    v_exp_f32 v103, v87
    v_exp_f32 v104, v88
    v_mfma_f32_32x32x16_bf16 v[64:79], v[220:223], v[184:187], v[64:79]
    v_exp_f32 v105, v89
    v_exp_f32 v106, v90
    v_exp_f32 v107, v91
    v_mfma_f32_32x32x16_bf16 v[64:79], v[224:227], v[200:203], v[64:79]
    v_exp_f32 v108, v92
    v_exp_f32 v109, v93
    v_exp_f32 v110, v94
    v_exp_f32 v111, v95
    v_add_u32_sdwa v248, s76, v243 dst_sel:DWORD dst_unused:UNUSED_PAD src0_sel:WORD_0 src1_sel:DWORD
    ds_read_b32 v230, v248 offset:0
    ds_read_b32 v232, v248 offset:128
    ds_read_b32 v234, v248 offset:256
    ds_read_b32 v236, v248 offset:384
    v_pk_fma_f32 v[228:229], v[114:115], v[96:97], v[114:115]
    v_pk_fma_f32 v[114:115], v[80:81], v[122:123], v[228:229]
    v_pk_fma_f32 v[122:123], v[122:123], v[96:97], v[122:123]
    v_rcp_f32 v36, v122
    v_rcp_f32 v37, v123
    v_pk_mul_f32 v[38:39], v[122:123], 0 op_sel_hi:[1,0]
    v_pk_fma_f32 v[38:39], v[114:115], v[36:37], v[38:39]
    v_pk_add_f32 v[122:123], v[98:99], 1.0 op_sel_hi:[1,0]
    v_add_f32 v33, v38, v39
    v_pk_fma_f32 v[228:229], v[82:83], v[100:101], v[82:83]
    v_pk_fma_f32 v[114:115], v[84:85], v[122:123], v[228:229]
    v_pk_fma_f32 v[122:123], v[122:123], v[100:101], v[122:123]
    v_pk_fma_f32 v[228:229], v[114:115], v[102:103], v[114:115]
    v_pk_fma_f32 v[114:115], v[86:87], v[122:123], v[228:229]
    v_pk_fma_f32 v[122:123], v[122:123], v[102:103], v[122:123]
    v_pk_fma_f32 v[228:229], v[114:115], v[104:105], v[114:115]
    v_pk_fma_f32 v[114:115], v[88:89], v[122:123], v[228:229]
    v_pk_fma_f32 v[122:123], v[122:123], v[104:105], v[122:123]
    v_pk_fma_f32 v[228:229], v[114:115], v[106:107], v[114:115]
    v_pk_fma_f32 v[114:115], v[90:91], v[122:123], v[228:229]
    v_pk_fma_f32 v[122:123], v[122:123], v[106:107], v[122:123]
    v_pk_fma_f32 v[228:229], v[114:115], v[108:109], v[114:115]
    v_pk_fma_f32 v[114:115], v[92:93], v[122:123], v[228:229]
    v_pk_fma_f32 v[122:123], v[122:123], v[108:109], v[122:123]
    v_pk_fma_f32 v[228:229], v[114:115], v[110:111], v[114:115]
    v_pk_fma_f32 v[114:115], v[94:95], v[122:123], v[228:229]
    v_pk_fma_f32 v[122:123], v[122:123], v[110:111], v[122:123]
    v_mfma_f32_32x32x16_bf16 v[80:95], v[208:211], v[140:143], 0
    v_exp_f32 v96, v64
    v_exp_f32 v97, v65
    v_exp_f32 v98, v66
    v_mfma_f32_32x32x16_bf16 v[80:95], v[212:215], v[156:159], v[80:95]
    v_exp_f32 v99, v67
    v_exp_f32 v100, v68
    v_exp_f32 v101, v69
    v_mfma_f32_32x32x16_bf16 v[80:95], v[216:219], v[172:175], v[80:95]
    v_exp_f32 v102, v70
    v_exp_f32 v103, v71
    v_exp_f32 v104, v72
    v_mfma_f32_32x32x16_bf16 v[80:95], v[220:223], v[188:191], v[80:95]
    v_exp_f32 v105, v73
    v_exp_f32 v106, v74
    v_exp_f32 v107, v75
    v_mfma_f32_32x32x16_bf16 v[80:95], v[224:227], v[204:207], v[80:95]
    v_exp_f32 v108, v76
    v_exp_f32 v109, v77
    v_exp_f32 v110, v78
    v_exp_f32 v111, v79
    s_waitcnt vmcnt(0)
    ds_read_b128 v[208:211], v238
    ds_read_b128 v[212:215], v239
    ds_read_b128 v[216:219], v240
    ds_read_b128 v[220:223], v241
    v_add_u32_sdwa v249, s74, v242 dst_sel:DWORD dst_unused:UNUSED_PAD src0_sel:WORD_0 src1_sel:DWORD
    ds_read_b128 v[224:227], v249
    s_bitcmp1_b32 s75, 5
    s_cbranch_scc0 NQR_b1
    s_and_b32 s81, s75, 0xfe00fe00
    v_add_u32_sdwa v250, s81, v244 dst_sel:DWORD dst_unused:UNUSED_PAD src0_sel:WORD_0 src1_sel:DWORD
    v_add_u32_sdwa v40, s81, v244 dst_sel:DWORD dst_unused:UNUSED_PAD src0_sel:WORD_1 src1_sel:DWORD
    ds_read2_b32 v[44:45], v250 offset0:0 offset1:32
    ds_read2_b32 v[48:49], v40 offset0:0 offset1:32
    ds_read2_b32 v[46:47], v250 offset0:64 offset1:96
    ds_read2_b32 v[50:51], v40 offset0:64 offset1:96
NQR_b1:
    v_pk_fma_f32 v[228:229], v[116:117], v[96:97], v[116:117]
    v_pk_fma_f32 v[116:117], v[64:65], v[124:125], v[228:229]
    v_pk_fma_f32 v[124:125], v[124:125], v[96:97], v[124:125]
    v_rcp_f32 v36, v124
    v_rcp_f32 v37, v125
    v_pk_mul_f32 v[38:39], v[124:125], 0 op_sel_hi:[1,0]
    v_pk_fma_f32 v[38:39], v[116:117], v[36:37], v[38:39]
    v_pk_add_f32 v[124:125], v[98:99], 1.0 op_sel_hi:[1,0]
    v_add_f32 v34, v38, v39
    v_pk_fma_f32 v[228:229], v[66:67], v[100:101], v[66:67]
    v_pk_fma_f32 v[116:117], v[68:69], v[124:125], v[228:229]
    v_pk_fma_f32 v[124:125], v[124:125], v[100:101], v[124:125]
    v_pk_fma_f32 v[228:229], v[116:117], v[102:103], v[116:117]
    v_pk_fma_f32 v[116:117], v[70:71], v[124:125], v[228:229]
    v_pk_fma_f32 v[124:125], v[124:125], v[102:103], v[124:125]
    v_pk_fma_f32 v[228:229], v[116:117], v[104:105], v[116:117]
    v_pk_fma_f32 v[116:117], v[72:73], v[124:125], v[228:229]
    v_pk_fma_f32 v[124:125], v[124:125], v[104:105], v[124:125]
    v_pk_fma_f32 v[228:229], v[116:117], v[106:107], v[116:117]
    v_pk_fma_f32 v[116:117], v[74:75], v[124:125], v[228:229]
    v_pk_fma_f32 v[124:125], v[124:125], v[106:107], v[124:125]
    v_pk_fma_f32 v[228:229], v[116:117], v[108:109], v[116:117]
    v_pk_fma_f32 v[116:117], v[76:77], v[124:125], v[228:229]
    v_pk_fma_f32 v[124:125], v[124:125], v[108:109], v[124:125]
    v_pk_fma_f32 v[228:229], v[116:117], v[110:111], v[116:117]
    v_pk_fma_f32 v[116:117], v[78:79], v[124:125], v[228:229]
    v_pk_fma_f32 v[124:125], v[124:125], v[110:111], v[124:125]
    s_waitcnt lgkmcnt(0)
    s_bitcmp1_b32 s75, 5
    s_cbranch_scc0 NQM_b1
    v_perm_b32 v195, v48, v44, v41
    v_perm_b32 v199, v49, v45, v41
    v_perm_b32 v203, v50, v46, v41
    v_perm_b32 v207, v51, v47, v41
NQM_b1:
    v_mfma_f32_32x32x16_bf16 v[64:79], v[208:211], v[128:131], 0
    v_exp_f32 v96, v80
    v_exp_f32 v97, v81
    v_exp_f32 v98, v82
    v_mfma_f32_32x32x16_bf16 v[64:79], v[212:215], v[144:147], v[64:79]
    v_exp_f32 v99, v83
    v_exp_f32 v100, v84
    v_exp_f32 v101, v85
    v_mfma_f32_32x32x16_bf16 v[64:79], v[216:219], v[160:163], v[64:79]
    v_exp_f32 v102, v86
    v_exp_f32 v103, v87
    v_exp_f32 v104, v88
    v_mfma_f32_32x32x16_bf16 v[64:79], v[220:223], v[176:179], v[64:79]
    v_exp_f32 v105, v89
    v_exp_f32 v106, v90
    v_exp_f32 v107, v91
    v_mfma_f32_32x32x16_bf16 v[64:79], v[224:227], v[192:195], v[64:79]
    v_exp_f32 v108, v92
    v_exp_f32 v109, v93
    v_exp_f32 v110, v94
    v_exp_f32 v111, v95
    buffer_load_dwordx4 v[230:231], s[12:15], 0 idxen offen offset:0 lds
    buffer_load_dwordx4 v[232:233], s[12:15], 0 idxen offen offset:1024 lds
    buffer_load_dwordx4 v[234:235], s[12:15], 0 idxen offen offset:2048 lds
    buffer_load_dwordx4 v[236:237], s[12:15], 0 idxen offen offset:3072 lds
    v_add_u32_sdwa v251, s72, v246 dst_sel:DWORD dst_unused:UNUSED_PAD src0_sel:WORD_1 src1_sel:DWORD
    ds_read2st64_b32 v[252:253], v251 offset0:0 offset1:1
    v_pk_fma_f32 v[228:229], v[118:119], v[96:97], v[118:119]
    v_pk_fma_f32 v[118:119], v[80:81], v[126:127], v[228:229]
    v_pk_fma_f32 v[126:127], v[126:127], v[96:97], v[126:127]
    v_rcp_f32 v36, v126
    v_rcp_f32 v37, v127
    v_pk_mul_f32 v[38:39], v[126:127], 0 op_sel_hi:[1,0]
    v_pk_fma_f32 v[38:39], v[118:119], v[36:37], v[38:39]
    v_pk_add_f32 v[126:127], v[98:99], 1.0 op_sel_hi:[1,0]
    v_add_f32 v35, v38, v39
    v_pk_fma_f32 v[228:229], v[82:83], v[100:101], v[82:83]
    v_pk_fma_f32 v[118:119], v[84:85], v[126:127], v[228:229]
    v_pk_fma_f32 v[126:127], v[126:127], v[100:101], v[126:127]
    v_pk_fma_f32 v[228:229], v[118:119], v[102:103], v[118:119]
    v_pk_fma_f32 v[118:119], v[86:87], v[126:127], v[228:229]
    v_pk_fma_f32 v[126:127], v[126:127], v[102:103], v[126:127]
    v_pk_fma_f32 v[228:229], v[118:119], v[104:105], v[118:119]
    v_pk_fma_f32 v[118:119], v[88:89], v[126:127], v[228:229]
    v_pk_fma_f32 v[126:127], v[126:127], v[104:105], v[126:127]
    v_pk_fma_f32 v[228:229], v[118:119], v[106:107], v[118:119]
    v_pk_fma_f32 v[118:119], v[90:91], v[126:127], v[228:229]
    v_pk_fma_f32 v[126:127], v[126:127], v[106:107], v[126:127]
    v_pk_fma_f32 v[228:229], v[118:119], v[108:109], v[118:119]
    v_pk_fma_f32 v[118:119], v[92:93], v[126:127], v[228:229]
    v_pk_fma_f32 v[126:127], v[126:127], v[108:109], v[126:127]
    v_pk_fma_f32 v[228:229], v[118:119], v[110:111], v[118:119]
    v_pk_fma_f32 v[118:119], v[94:95], v[126:127], v[228:229]
    v_pk_fma_f32 v[126:127], v[126:127], v[110:111], v[126:127]
    s_nop 1
    v_permlane32_swap_b32 v32, v33
    v_permlane32_swap_b32 v34, v35
    v_add_f32 v32, v32, v33
    v_add_f32 v34, v34, v35
    s_waitcnt lgkmcnt(0)
    v_add_f32 v32, v32, v252
    v_add_f32 v34, v34, v253
    ds_write2st64_b32 v251, v32, v34 offset0:0 offset1:1
    s_cmp_lt_u32 s101, s95
    s_cbranch_scc1 NP_b1
    s_setprio 0
NP_b1:
    s_bitcmp1_b32 s73, 4
    s_cbranch_scc1 FLUSHB
    s_mov_b64 s[72:73], s[74:75]
    s_mov_b64 s[74:75], s[76:77]
    v_readlane_b32 s76, v247, s101
    v_readlane_b32 s77, v245, s101
    s_add_u32 s101, s101, 1
    s_and_b32 s84, s73, 15
    s_mul_i32 s85, s84, s3
    s_add_u32 s90, s10, s85
    s_addc_u32 s91, s11, 0
    s_setpc_b64 s[90:91]
.p2align 11
BT2:
    v_mfma_f32_32x32x16_bf16 v[80:95], v[208:211], v[132:135], 0
    v_exp_f32 v96, v64
    v_exp_f32 v97, v65
    v_exp_f32 v98, v66
    v_mfma_f32_32x32x16_bf16 v[80:95], v[212:215], v[148:151], v[80:95]
    v_exp_f32 v99, v67
    v_exp_f32 v100, v68
    v_exp_f32 v101, v69
    v_mfma_f32_32x32x16_bf16 v[80:95], v[216:219], v[164:167], v[80:95]
    v_exp_f32 v102, v70
    v_exp_f32 v103, v71
    v_exp_f32 v104, v72
    v_mfma_f32_32x32x16_bf16 v[80:95], v[220:223], v[180:183], v[80:95]
    v_exp_f32 v105, v73
    v_exp_f32 v106, v74
    v_exp_f32 v107, v75
    v_mfma_f32_32x32x16_bf16 v[80:95], v[224:227], v[196:199], v[80:95]
    v_exp_f32 v108, v76
    v_exp_f32 v109, v77
    v_exp_f32 v110, v78
    v_exp_f32 v111, v79
    v_pk_fma_f32 v[228:229], v[112:113], v[96:97], v[112:113]
    v_pk_fma_f32 v[112:113], v[64:65], v[120:121], v[228:229]
    v_pk_fma_f32 v[120:121], v[120:121], v[96:97], v[120:121]
    v_pk_fma_f32 v[228:229], v[112:113], v[98:99], v[112:113]
    v_pk_fma_f32 v[112:113], v[66:67], v[120:121], v[228:229]
    v_pk_fma_f32 v[120:121], v[120:121], v[98:99], v[120:121]
    v_rcp_f32 v36, v120
    v_rcp_f32 v37, v121
    v_pk_mul_f32 v[38:39], v[120:121], 0 op_sel_hi:[1,0]
    v_pk_fma_f32 v[38:39], v[112:113], v[36:37], v[38:39]
    v_pk_add_f32 v[120:121], v[100:101], 1.0 op_sel_hi:[1,0]
    v_add_f32 v32, v38, v39
    v_pk_fma_f32 v[228:229], v[68:69], v[102:103], v[68:69]
    v_pk_fma_f32 v[112:113], v[70:71], v[120:121], v[228:229]
    v_pk_fma_f32 v[120:121], v[120:121], v[102:103], v[120:121]
    v_pk_fma_f32 v[228:229], v[112:113], v[104:105], v[112:113]
    v_pk_fma_f32 v[112:113], v[72:73], v[120:121], v[228:229]
    v_pk_fma_f32 v[120:121], v[120:121], v[104:105], v[120:121]
    v_pk_fma_f32 v[228:229], v[112:113], v[106:107], v[112:113]
    v_pk_fma_f32 v[112:113], v[74:75], v[120:121], v[228:229]
    v_pk_fma_f32 v[120:121], v[120:121], v[106:107], v[120:121]
    v_pk_fma_f32 v[228:229], v[112:113], v[108:109], v[112:113]
    v_pk_fma_f32 v[112:113], v[76:77], v[120:121], v[228:229]
    v_pk_fma_f32 v[120:121], v[120:121], v[108:109], v[120:121]
    v_pk_fma_f32 v[228:229], v[112:113], v[110:111], v[112:113]
    v_pk_fma_f32 v[112:113], v[78:79], v[120:121], v[228:229]
    v_pk_fma_f32 v[120:121], v[120:121], v[110:111], v[120:121]
    v_mfma_f32_32x32x16_bf16 v[64:79], v[208:211], v[136:139], 0
    v_exp_f32 v96, v80
    v_exp_f32 v97, v81
    v_exp_f32 v98, v82
    v_mfma_f32_32x32x16_bf16 v[64:79], v[212:215], v[152:155], v[64:79]
    v_exp_f32 v99, v83
    v_exp_f32 v100, v84
    v_exp_f32 v101, v85
    v_mfma_f32_32x32x16_bf16 v[64:79], v[216:219], v[168:171], v[64:79]
    v_exp_f32 v102, v86
    v_exp_f32 v103, v87
    v_exp_f32 v104, v88
    v_mfma_f32_32x32x16_bf16 v[64:79], v[220:223], v[184:187], v[64:79]
    v_exp_f32 v105, v89
    v_exp_f32 v106, v90
    v_exp_f32 v107, v91
    v_mfma_f32_32x32x16_bf16 v[64:79], v[224:227], v[200:203], v[64:79]
    v_exp_f32 v108, v92
    v_exp_f32 v109, v93
    v_exp_f32 v110, v94
    v_exp_f32 v111, v95
    v_add_u32_sdwa v248, s76, v243 dst_sel:DWORD dst_unused:UNUSED_PAD src0_sel:WORD_0 src1_sel:DWORD
    ds_read_b32 v230, v248 offset:0
    ds_read_b32 v232, v248 offset:128
    ds_read_b32 v234, v248 offset:256
    ds_read_b32 v236, v248 offset:384
    v_pk_fma_f32 v[228:229], v[114:115], v[96:97], v[114:115]
    v_pk_fma_f32 v[114:115], v[80:81], v[122:123], v[228:229]
    v_pk_fma_f32 v[122:123], v[122:123], v[96:97], v[122:123]
    v_pk_fma_f32 v[228:229], v[114:115], v[98:99], v[114:115]
    v_pk_fma_f32 v[114:115], v[82:83], v[122:123], v[228:229]
    v_pk_fma_f32 v[122:123], v[122:123], v[98:99], v[122:123]
    v_rcp_f32 v36, v122
    v_rcp_f32 v37, v123
    v_pk_mul_f32 v[38:39], v[122:123], 0 op_sel_hi:[1,0]
    v_pk_fma_f32 v[38:39], v[114:115], v[36:37], v[38:39]
    v_pk_add_f32 v[122:123], v[100:101], 1.0 op_sel_hi:[1,0]
    v_add_f32 v33, v38, v39
    v_pk_fma_f32 v[228:229], v[84:85], v[102:103], v[84:85]
    v_pk_fma_f32 v[114:115], v[86:87], v[122:123], v[228:229]
    v_pk_fma_f32 v[122:123], v[122:123], v[102:103], v[122:123]
    v_pk_fma_f32 v[228:229], v[114:115], v[104:105], v[114:115]
    v_pk_fma_f32 v[114:115], v[88:89], v[122:123], v[228:229]
    v_pk_fma_f32 v[122:123], v[122:123], v[104:105], v[122:123]
    v_pk_fma_f32 v[228:229], v[114:115], v[106:107], v[114:115]
    v_pk_fma_f32 v[114:115], v[90:91], v[122:123], v[228:229]
    v_pk_fma_f32 v[122:123], v[122:123], v[106:107], v[122:123]
    v_pk_fma_f32 v[228:229], v[114:115], v[108:109], v[114:115]
    v_pk_fma_f32 v[114:115], v[92:93], v[122:123], v[228:229]
    v_pk_fma_f32 v[122:123], v[122:123], v[108:109], v[122:123]
    v_pk_fma_f32 v[228:229], v[114:115], v[110:111], v[114:115]
    v_pk_fma_f32 v[114:115], v[94:95], v[122:123], v[228:229]
    v_pk_fma_f32 v[122:123], v[122:123], v[110:111], v[122:123]
    v_mfma_f32_32x32x16_bf16 v[80:95], v[208:211], v[140:143], 0
    v_exp_f32 v96, v64
    v_exp_f32 v97, v65
    v_exp_f32 v98, v66
    v_mfma_f32_32x32x16_bf16 v[80:95], v[212:215], v[156:159], v[80:95]
    v_exp_f32 v99, v67
    v_exp_f32 v100, v68
    v_exp_f32 v101, v69
    v_mfma_f32_32x32x16_bf16 v[80:95], v[216:219], v[172:175], v[80:95]
    v_exp_f32 v102, v70
    v_exp_f32 v103, v71
    v_exp_f32 v104, v72
    v_mfma_f32_32x32x16_bf16 v[80:95], v[220:223], v[188:191], v[80:95]
    v_exp_f32 v105, v73
    v_exp_f32 v106, v74
    v_exp_f32 v107, v75
    v_mfma_f32_32x32x16_bf16 v[80:95], v[224:227], v[204:207], v[80:95]
    v_exp_f32 v108, v76
    v_exp_f32 v109, v77
    v_exp_f32 v110, v78
    v_exp_f32 v111, v79
    s_waitcnt vmcnt(0)
    ds_read_b128 v[208:211], v238
    ds_read_b128 v[212:215], v239
    ds_read_b128 v[216:219], v240
    ds_read_b128 v[220:223], v241
    v_add_u32_sdwa v249, s74, v242 dst_sel:DWORD dst_unused:UNUSED_PAD src0_sel:WORD_0 src1_sel:DWORD
    ds_read_b128 v[224:227], v249
    s_bitcmp1_b32 s75, 5
    s_cbranch_scc0 NQR_b2
    s_and_b32 s81, s75, 0xfe00fe00
    v_add_u32_sdwa v250, s81, v244 dst_sel:DWORD dst_unused:UNUSED_PAD src0_sel:WORD_0 src1_sel:DWORD
    v_add_u32_sdwa v40, s81, v244 dst_sel:DWORD dst_unused:UNUSED_PAD src0_sel:WORD_1 src1_sel:DWORD
    ds_read2_b32 v[44:45], v250 offset0:0 offset1:32
    ds_read2_b32 v[48:49], v40 offset0:0 offset1:32
    ds_read2_b32 v[46:47], v250 offset0:64 offset1:96
    ds_read2_b32 v[50:51], v40 offset0:64 offset1:96
NQR_b2:
    v_pk_fma_f32 v[228:229], v[116:117], v[96:97], v[116:117]
    v_pk_fma_f32 v[116:117], v[64:65], v[124:125], v[228:229]
    v_pk_fma_f32 v[124:125], v[124:125], v[96:97], v[124:125]
    v_pk_fma_f32 v[228:229], v[116:117], v[98:99], v[116:117]
    v_pk_fma_f32 v[116:117], v[66:67], v[124:125], v[228:229]
    v_pk_fma_f32 v[124:125], v[124:125], v[98:99], v[124:125]
    v_rcp_f32 v36, v124
    v_rcp_f32 v37, v125
    v_pk_mul_f32 v[38:39], v[124:125], 0 op_sel_hi:[1,0]
    v_pk_fma_f32 v[38:39], v[116:117], v[36:37], v[38:39]
    v_pk_add_f32 v[124:125], v[100:101], 1.0 op_sel_hi:[1,0]
    v_add_f32 v34, v38, v39
    v_pk_fma_f32 v[228:229], v[68:69], v[102:103], v[68:69]
    v_pk_fma_f32 v[116:117], v[70:71], v[124:125], v[228:229]
    v_pk_fma_f32 v[124:125], v[124:125], v[102:103], v[124:125]
    v_pk_fma_f32 v[228:229], v[116:117], v[104:105], v[116:117]
    v_pk_fma_f32 v[116:117], v[72:73], v[124:125], v[228:229]
    v_pk_fma_f32 v[124:125], v[124:125], v[104:105], v[124:125]
    v_pk_fma_f32 v[228:229], v[116:117], v[106:107], v[116:117]
    v_pk_fma_f32 v[116:117], v[74:75], v[124:125], v[228:229]
    v_pk_fma_f32 v[124:125], v[124:125], v[106:107], v[124:125]
    v_pk_fma_f32 v[228:229], v[116:117], v[108:109], v[116:117]
    v_pk_fma_f32 v[116:117], v[76:77], v[124:125], v[228:229]
    v_pk_fma_f32 v[124:125], v[124:125], v[108:109], v[124:125]
    v_pk_fma_f32 v[228:229], v[116:117], v[110:111], v[116:117]
    v_pk_fma_f32 v[116:117], v[78:79], v[124:125], v[228:229]
    v_pk_fma_f32 v[124:125], v[124:125], v[110:111], v[124:125]
    s_waitcnt lgkmcnt(0)
    s_bitcmp1_b32 s75, 5
    s_cbranch_scc0 NQM_b2
    v_perm_b32 v195, v48, v44, v41
    v_perm_b32 v199, v49, v45, v41
    v_perm_b32 v203, v50, v46, v41
    v_perm_b32 v207, v51, v47, v41
NQM_b2:
    v_mfma_f32_32x32x16_bf16 v[64:79], v[208:211], v[128:131], 0
    v_exp_f32 v96, v80
    v_exp_f32 v97, v81
    v_exp_f32 v98, v82
    v_mfma_f32_32x32x16_bf16 v[64:79], v[212:215], v[144:147], v[64:79]
    v_exp_f32 v99, v83
    v_exp_f32 v100, v84
    v_exp_f32 v101, v85
    v_mfma_f32_32x32x16_bf16 v[64:79], v[216:219], v[160:163], v[64:79]
    v_exp_f32 v102, v86
    v_exp_f32 v103, v87
    v_exp_f32 v104, v88
    v_mfma_f32_32x32x16_bf16 v[64:79], v[220:223], v[176:179], v[64:79]
    v_exp_f32 v105, v89
    v_exp_f32 v106, v90
    v_exp_f32 v107, v91
    v_mfma_f32_32x32x16_bf16 v[64:79], v[224:227], v[192:195], v[64:79]
    v_exp_f32 v108, v92
    v_exp_f32 v109, v93
    v_exp_f32 v110, v94
    v_exp_f32 v111, v95
    buffer_load_dwordx4 v[230:231], s[12:15], 0 idxen offen offset:0 lds
    buffer_load_dwordx4 v[232:233], s[12:15], 0 idxen offen offset:1024 lds
    buffer_load_dwordx4 v[234:235], s[12:15], 0 idxen offen offset:2048 lds
    buffer_load_dwordx4 v[236:237], s[12:15], 0 idxen offen offset:3072 lds
    v_add_u32_sdwa v251, s72, v246 dst_sel:DWORD dst_unused:UNUSED_PAD src0_sel:WORD_1 src1_sel:DWORD
    ds_read2st64_b32 v[252:253], v251 offset0:0 offset1:1
    v_pk_fma_f32 v[228:229], v[118:119], v[96:97], v[118:119]
    v_pk_fma_f32 v[118:119], v[80:81], v[126:127], v[228:229]
    v_pk_fma_f32 v[126:127], v[126:127], v[96:97], v[126:127]
    v_pk_fma_f32 v[228:229], v[118:119], v[98:99], v[118:119]
    v_pk_fma_f32 v[118:119], v[82:83], v[126:127], v[228:229]
    v_pk_fma_f32 v[126:127], v[126:127], v[98:99], v[126:127]
    v_rcp_f32 v36, v126
    v_rcp_f32 v37, v127
    v_pk_mul_f32 v[38:39], v[126:127], 0 op_sel_hi:[1,0]
    v_pk_fma_f32 v[38:39], v[118:119], v[36:37], v[38:39]
    v_pk_add_f32 v[126:127], v[100:101], 1.0 op_sel_hi:[1,0]
    v_add_f32 v35, v38, v39
    v_pk_fma_f32 v[228:229], v[84:85], v[102:103], v[84:85]
    v_pk_fma_f32 v[118:119], v[86:87], v[126:127], v[228:229]
    v_pk_fma_f32 v[126:127], v[126:127], v[102:103], v[126:127]
    v_pk_fma_f32 v[228:229], v[118:119], v[104:105], v[118:119]
    v_pk_fma_f32 v[118:119], v[88:89], v[126:127], v[228:229]
    v_pk_fma_f32 v[126:127], v[126:127], v[104:105], v[126:127]
    v_pk_fma_f32 v[228:229], v[118:119], v[106:107], v[118:119]
    v_pk_fma_f32 v[118:119], v[90:91], v[126:127], v[228:229]
    v_pk_fma_f32 v[126:127], v[126:127], v[106:107], v[126:127]
    v_pk_fma_f32 v[228:229], v[118:119], v[108:109], v[118:119]
    v_pk_fma_f32 v[118:119], v[92:93], v[126:127], v[228:229]
    v_pk_fma_f32 v[126:127], v[126:127], v[108:109], v[126:127]
    v_pk_fma_f32 v[228:229], v[118:119], v[110:111], v[118:119]
    v_pk_fma_f32 v[118:119], v[94:95], v[126:127], v[228:229]
    v_pk_fma_f32 v[126:127], v[126:127], v[110:111], v[126:127]
    s_nop 1
    v_permlane32_swap_b32 v32, v33
    v_permlane32_swap_b32 v34, v35
    v_add_f32 v32, v32, v33
    v_add_f32 v34, v34, v35
    s_waitcnt lgkmcnt(0)
    v_add_f32 v32, v32, v252
    v_add_f32 v34, v34, v253
    ds_write2st64_b32 v251, v32, v34 offset0:0 offset1:1
    s_cmp_lt_u32 s101, s95
    s_cbranch_scc1 NP_b2
    s_setprio 0
NP_b2:
    s_bitcmp1_b32 s73, 4
    s_cbranch_scc1 FLUSHB
    s_mov_b64 s[72:73], s[74:75]
    s_mov_b64 s[74:75], s[76:77]
    v_readlane_b32 s76, v247, s101
    v_readlane_b32 s77, v245, s101
    s_add_u32 s101, s101, 1
    s_and_b32 s84, s73, 15
    s_mul_i32 s85, s84, s3
    s_add_u32 s90, s10, s85
    s_addc_u32 s91, s11, 0
    s_setpc_b64 s[90:91]
.p2align 11
BT3:
    v_mfma_f32_32x32x16_bf16 v[80:95], v[208:211], v[132:135], 0
    v_exp_f32 v96, v64
    v_exp_f32 v97, v65
    v_exp_f32 v98, v66
    v_mfma_f32_32x32x16_bf16 v[80:95], v[212:215], v[148:151], v[80:95]
    v_exp_f32 v99, v67
    v_exp_f32 v100, v68
    v_exp_f32 v101, v69
    v_mfma_f32_32x32x16_bf16 v[80:95], v[216:219], v[164:167], v[80:95]
    v_exp_f32 v102, v70
    v_exp_f32 v103, v71
    v_exp_f32 v104, v72
    v_mfma_f32_32x32x16_bf16 v[80:95], v[220:223], v[180:183], v[80:95]
    v_exp_f32 v105, v73
    v_exp_f32 v106, v74
    v_exp_f32 v107, v75
    v_mfma_f32_32x32x16_bf16 v[80:95], v[224:227], v[196:199], v[80:95]
    v_exp_f32 v108, v76
    v_exp_f32 v109, v77
    v_exp_f32 v110, v78
    v_exp_f32 v111, v79
    v_pk_fma_f32 v[228:229], v[112:113], v[96:97], v[112:113]
    v_pk_fma_f32 v[112:113], v[64:65], v[120:121], v[228:229]
    v_pk_fma_f32 v[120:121], v[120:121], v[96:97], v[120:121]
    v_pk_fma_f32 v[228:229], v[112:113], v[98:99], v[112:113]
    v_pk_fma_f32 v[112:113], v[66:67], v[120:121], v[228:229]
    v_pk_fma_f32 v[120:121], v[120:121], v[98:99], v[120:121]
    v_pk_fma_f32 v[228:229], v[112:113], v[100:101], v[112:113]
    v_pk_fma_f32 v[112:113], v[68:69], v[120:121], v[228:229]
    v_pk_fma_f32 v[120:121], v[120:121], v[100:101], v[120:121]
    v_rcp_f32 v36, v120
    v_rcp_f32 v37, v121
    v_pk_mul_f32 v[38:39], v[120:121], 0 op_sel_hi:[1,0]
    v_pk_fma_f32 v[38:39], v[112:113], v[36:37], v[38:39]
    v_pk_add_f32 v[120:121], v[102:103], 1.0 op_sel_hi:[1,0]
    v_add_f32 v32, v38, v39
    v_pk_fma_f32 v[228:229], v[70:71], v[104:105], v[70:71]
    v_pk_fma_f32 v[112:113], v[72:73], v[120:121], v[228:229]
    v_pk_fma_f32 v[120:121], v[120:121], v[104:105], v[120:121]
    v_pk_fma_f32 v[228:229], v[112:113], v[106:107], v[112:113]
    v_pk_fma_f32 v[112:113], v[74:75], v[120:121], v[228:229]
    v_pk_fma_f32 v[120:121], v[120:121], v[106:107], v[120:121]
    v_pk_fma_f32 v[228:229], v[112:113], v[108:109], v[112:113]
    v_pk_fma_f32 v[112:113], v[76:77], v[120:121], v[228:229]
    v_pk_fma_f32 v[120:121], v[120:121], v[108:109], v[120:121]
    v_pk_fma_f32 v[228:229], v[112:113], v[110:111], v[112:113]
    v_pk_fma_f32 v[112:113], v[78:79], v[120:121], v[228:229]
    v_pk_fma_f32 v[120:121], v[120:121], v[110:111], v[120:121]
    v_mfma_f32_32x32x16_bf16 v[64:79], v[208:211], v[136:139], 0
    v_exp_f32 v96, v80
    v_exp_f32 v97, v81
    v_exp_f32 v98, v82
    v_mfma_f32_32x32x16_bf16 v[64:79], v[212:215], v[152:155], v[64:79]
    v_exp_f32 v99, v83
    v_exp_f32 v100, v84
    v_exp_f32 v101, v85
    v_mfma_f32_32x32x16_bf16 v[64:79], v[216:219], v[168:171], v[64:79]
    v_exp_f32 v102, v86
    v_exp_f32 v103, v87
    v_exp_f32 v104, v88
    v_mfma_f32_32x32x16_bf16 v[64:79], v[220:223], v[184:187], v[64:79]
    v_exp_f32 v105, v89
    v_exp_f32 v106, v90
    v_exp_f32 v107, v91
    v_mfma_f32_32x32x16_bf16 v[64:79], v[224:227], v[200:203], v[64:79]
    v_exp_f32 v108, v92
    v_exp_f32 v109, v93
    v_exp_f32 v110, v94
    v_exp_f32 v111, v95
    v_add_u32_sdwa v248, s76, v243 dst_sel:DWORD dst_unused:UNUSED_PAD src0_sel:WORD_0 src1_sel:DWORD
    ds_read_b32 v230, v248 offset:0
    ds_read_b32 v232, v248 offset:128
    ds_read_b32 v234, v248 offset:256
    ds_read_b32 v236, v248 offset:384
    v_pk_fma_f32 v[228:229], v[114:115], v[96:97], v[114:115]
    v_pk_fma_f32 v[114:115], v[80:81], v[122:123], v[228:229]
    v_pk_fma_f32 v[122:123], v[122:123], v[96:97], v[122:123]
    v_pk_fma_f32 v[228:229], v[114:115], v[98:99], v[114:115]
    v_pk_fma_f32 v[114:115], v[82:83], v[122:123], v[228:229]
    v_pk_fma_f32 v[122:123], v[122:123], v[98:99], v[122:123]
    v_pk_fma_f32 v[228:229], v[114:115], v[100:101], v[114:115]
    v_pk_fma_f32 v[114:115], v[84:85], v[122:123], v[228:229]
    v_pk_fma_f32 v[122:123], v[122:123], v[100:101], v[122:123]
    v_rcp_f32 v36, v122
    v_rcp_f32 v37, v123
    v_pk_mul_f32 v[38:39], v[122:123], 0 op_sel_hi:[1,0]
    v_pk_fma_f32 v[38:39], v[114:115], v[36:37], v[38:39]
    v_pk_add_f32 v[122:123], v[102:103], 1.0 op_sel_hi:[1,0]
    v_add_f32 v33, v38, v39
    v_pk_fma_f32 v[228:229], v[86:87], v[104:105], v[86:87]
    v_pk_fma_f32 v[114:115], v[88:89], v[122:123], v[228:229]
    v_pk_fma_f32 v[122:123], v[122:123], v[104:105], v[122:123]
    v_pk_fma_f32 v[228:229], v[114:115], v[106:107], v[114:115]
    v_pk_fma_f32 v[114:115], v[90:91], v[122:123], v[228:229]
    v_pk_fma_f32 v[122:123], v[122:123], v[106:107], v[122:123]
    v_pk_fma_f32 v[228:229], v[114:115], v[108:109], v[114:115]
    v_pk_fma_f32 v[114:115], v[92:93], v[122:123], v[228:229]
    v_pk_fma_f32 v[122:123], v[122:123], v[108:109], v[122:123]
    v_pk_fma_f32 v[228:229], v[114:115], v[110:111], v[114:115]
    v_pk_fma_f32 v[114:115], v[94:95], v[122:123], v[228:229]
    v_pk_fma_f32 v[122:123], v[122:123], v[110:111], v[122:123]
    v_mfma_f32_32x32x16_bf16 v[80:95], v[208:211], v[140:143], 0
    v_exp_f32 v96, v64
    v_exp_f32 v97, v65
    v_exp_f32 v98, v66
    v_mfma_f32_32x32x16_bf16 v[80:95], v[212:215], v[156:159], v[80:95]
    v_exp_f32 v99, v67
    v_exp_f32 v100, v68
    v_exp_f32 v101, v69
    v_mfma_f32_32x32x16_bf16 v[80:95], v[216:219], v[172:175], v[80:95]
    v_exp_f32 v102, v70
    v_exp_f32 v103, v71
    v_exp_f32 v104, v72
    v_mfma_f32_32x32x16_bf16 v[80:95], v[220:223], v[188:191], v[80:95]
    v_exp_f32 v105, v73
    v_exp_f32 v106, v74
    v_exp_f32 v107, v75
    v_mfma_f32_32x32x16_bf16 v[80:95], v[224:227], v[204:207], v[80:95]
    v_exp_f32 v108, v76
    v_exp_f32 v109, v77
    v_exp_f32 v110, v78
    v_exp_f32 v111, v79
    s_waitcnt vmcnt(0)
    ds_read_b128 v[208:211], v238
    ds_read_b128 v[212:215], v239
    ds_read_b128 v[216:219], v240
    ds_read_b128 v[220:223], v241
    v_add_u32_sdwa v249, s74, v242 dst_sel:DWORD dst_unused:UNUSED_PAD src0_sel:WORD_0 src1_sel:DWORD
    ds_read_b128 v[224:227], v249
    s_bitcmp1_b32 s75, 5
    s_cbranch_scc0 NQR_b3
    s_and_b32 s81, s75, 0xfe00fe00
    v_add_u32_sdwa v250, s81, v244 dst_sel:DWORD dst_unused:UNUSED_PAD src0_sel:WORD_0 src1_sel:DWORD
    v_add_u32_sdwa v40, s81, v244 dst_sel:DWORD dst_unused:UNUSED_PAD src0_sel:WORD_1 src1_sel:DWORD
    ds_read2_b32 v[44:45], v250 offset0:0 offset1:32
    ds_read2_b32 v[48:49], v40 offset0:0 offset1:32
    ds_read2_b32 v[46:47], v250 offset0:64 offset1:96
    ds_read2_b32 v[50:51], v40 offset0:64 offset1:96
NQR_b3:
    v_pk_fma_f32 v[228:229], v[116:117], v[96:97], v[116:117]
    v_pk_fma_f32 v[116:117], v[64:65], v[124:125], v[228:229]
    v_pk_fma_f32 v[124:125], v[124:125], v[96:97], v[124:125]
    v_pk_fma_f32 v[228:229], v[116:117], v[98:99], v[116:117]
    v_pk_fma_f32 v[116:117], v[66:67], v[124:125], v[228:229]
    v_pk_fma_f32 v[124:125], v[124:125], v[98:99], v[124:125]
    v_pk_fma_f32 v[228:229], v[116:117], v[100:101], v[116:117]
    v_pk_fma_f32 v[116:117], v[68:69], v[124:125], v[228:229]
    v_pk_fma_f32 v[124:125], v[124:125], v[100:101], v[124:125]
    v_rcp_f32 v36, v124
    v_rcp_f32 v37, v125
    v_pk_mul_f32 v[38:39], v[124:125], 0 op_sel_hi:[1,0]
    v_pk_fma_f32 v[38:39], v[116:117], v[36:37], v[38:39]
    v_pk_add_f32 v[124:125], v[102:103], 1.0 op_sel_hi:[1,0]
    v_add_f32 v34, v38, v39
    v_pk_fma_f32 v[228:229], v[70:71], v[104:105], v[70:71]
    v_pk_fma_f32 v[116:117], v[72:73], v[124:125], v[228:229]
    v_pk_fma_f32 v[124:125], v[124:125], v[104:105], v[124:125]
    v_pk_fma_f32 v[228:229], v[116:117], v[106:107], v[116:117]
    v_pk_fma_f32 v[116:117], v[74:75], v[124:125], v[228:229]
    v_pk_fma_f32 v[124:125], v[124:125], v[106:107], v[124:125]
    v_pk_fma_f32 v[228:229], v[116:117], v[108:109], v[116:117]
    v_pk_fma_f32 v[116:117], v[76:77], v[124:125], v[228:229]
    v_pk_fma_f32 v[124:125], v[124:125], v[108:109], v[124:125]
    v_pk_fma_f32 v[228:229], v[116:117], v[110:111], v[116:117]
    v_pk_fma_f32 v[116:117], v[78:79], v[124:125], v[228:229]
    v_pk_fma_f32 v[124:125], v[124:125], v[110:111], v[124:125]
    s_waitcnt lgkmcnt(0)
    s_bitcmp1_b32 s75, 5
    s_cbranch_scc0 NQM_b3
    v_perm_b32 v195, v48, v44, v41
    v_perm_b32 v199, v49, v45, v41
    v_perm_b32 v203, v50, v46, v41
    v_perm_b32 v207, v51, v47, v41
NQM_b3:
    v_mfma_f32_32x32x16_bf16 v[64:79], v[208:211], v[128:131], 0
    v_exp_f32 v96, v80
    v_exp_f32 v97, v81
    v_exp_f32 v98, v82
    v_mfma_f32_32x32x16_bf16 v[64:79], v[212:215], v[144:147], v[64:79]
    v_exp_f32 v99, v83
    v_exp_f32 v100, v84
    v_exp_f32 v101, v85
    v_mfma_f32_32x32x16_bf16 v[64:79], v[216:219], v[160:163], v[64:79]
    v_exp_f32 v102, v86
    v_exp_f32 v103, v87
    v_exp_f32 v104, v88
    v_mfma_f32_32x32x16_bf16 v[64:79], v[220:223], v[176:179], v[64:79]
    v_exp_f32 v105, v89
    v_exp_f32 v106, v90
    v_exp_f32 v107, v91
    v_mfma_f32_32x32x16_bf16 v[64:79], v[224:227], v[192:195], v[64:79]
    v_exp_f32 v108, v92
    v_exp_f32 v109, v93
    v_exp_f32 v110, v94
    v_exp_f32 v111, v95
    buffer_load_dwordx4 v[230:231], s[12:15], 0 idxen offen offset:0 lds
    buffer_load_dwordx4 v[232:233], s[12:15], 0 idxen offen offset:1024 lds
    buffer_load_dwordx4 v[234:235], s[12:15], 0 idxen offen offset:2048 lds
    buffer_load_dwordx4 v[236:237], s[12:15], 0 idxen offen offset:3072 lds
    v_add_u32_sdwa v251, s72, v246 dst_sel:DWORD dst_unused:UNUSED_PAD src0_sel:WORD_1 src1_sel:DWORD
    ds_read2st64_b32 v[252:253], v251 offset0:0 offset1:1
    v_pk_fma_f32 v[228:229], v[118:119], v[96:97], v[118:119]
    v_pk_fma_f32 v[118:119], v[80:81], v[126:127], v[228:229]
    v_pk_fma_f32 v[126:127], v[126:127], v[96:97], v[126:127]
    v_pk_fma_f32 v[228:229], v[118:119], v[98:99], v[118:119]
    v_pk_fma_f32 v[118:119], v[82:83], v[126:127], v[228:229]
    v_pk_fma_f32 v[126:127], v[126:127], v[98:99], v[126:127]
    v_pk_fma_f32 v[228:229], v[118:119], v[100:101], v[118:119]
    v_pk_fma_f32 v[118:119], v[84:85], v[126:127], v[228:229]
    v_pk_fma_f32 v[126:127], v[126:127], v[100:101], v[126:127]
    v_rcp_f32 v36, v126
    v_rcp_f32 v37, v127
    v_pk_mul_f32 v[38:39], v[126:127], 0 op_sel_hi:[1,0]
    v_pk_fma_f32 v[38:39], v[118:119], v[36:37], v[38:39]
    v_pk_add_f32 v[126:127], v[102:103], 1.0 op_sel_hi:[1,0]
    v_add_f32 v35, v38, v39
    v_pk_fma_f32 v[228:229], v[86:87], v[104:105], v[86:87]
    v_pk_fma_f32 v[118:119], v[88:89], v[126:127], v[228:229]
    v_pk_fma_f32 v[126:127], v[126:127], v[104:105], v[126:127]
    v_pk_fma_f32 v[228:229], v[118:119], v[106:107], v[118:119]
    v_pk_fma_f32 v[118:119], v[90:91], v[126:127], v[228:229]
    v_pk_fma_f32 v[126:127], v[126:127], v[106:107], v[126:127]
    v_pk_fma_f32 v[228:229], v[118:119], v[108:109], v[118:119]
    v_pk_fma_f32 v[118:119], v[92:93], v[126:127], v[228:229]
    v_pk_fma_f32 v[126:127], v[126:127], v[108:109], v[126:127]
    v_pk_fma_f32 v[228:229], v[118:119], v[110:111], v[118:119]
    v_pk_fma_f32 v[118:119], v[94:95], v[126:127], v[228:229]
    v_pk_fma_f32 v[126:127], v[126:127], v[110:111], v[126:127]
    s_nop 1
    v_permlane32_swap_b32 v32, v33
    v_permlane32_swap_b32 v34, v35
    v_add_f32 v32, v32, v33
    v_add_f32 v34, v34, v35
    s_waitcnt lgkmcnt(0)
    v_add_f32 v32, v32, v252
    v_add_f32 v34, v34, v253
    ds_write2st64_b32 v251, v32, v34 offset0:0 offset1:1
    s_cmp_lt_u32 s101, s95
    s_cbranch_scc1 NP_b3
    s_setprio 0
NP_b3:
    s_bitcmp1_b32 s73, 4
    s_cbranch_scc1 FLUSHB
    s_mov_b64 s[72:73], s[74:75]
    s_mov_b64 s[74:75], s[76:77]
    v_readlane_b32 s76, v247, s101
    v_readlane_b32 s77, v245, s101
    s_add_u32 s101, s101, 1
    s_and_b32 s84, s73, 15
    s_mul_i32 s85, s84, s3
    s_add_u32 s90, s10, s85
    s_addc_u32 s91, s11, 0
    s_setpc_b64 s[90:91]
.p2align 11
BT4:
    v_mfma_f32_32x32x16_bf16 v[80:95], v[208:211], v[132:135], 0
    v_exp_f32 v96, v64
    v_exp_f32 v97, v65
    v_exp_f32 v98, v66
    v_mfma_f32_32x32x16_bf16 v[80:95], v[212:215], v[148:151], v[80:95]
    v_exp_f32 v99, v67
    v_exp_f32 v100, v68
    v_exp_f32 v101, v69
    v_mfma_f32_32x32x16_bf16 v[80:95], v[216:219], v[164:167], v[80:95]
    v_exp_f32 v102, v70
    v_exp_f32 v103, v71
    v_exp_f32 v104, v72
    v_mfma_f32_32x32x16_bf16 v[80:95], v[220:223], v[180:183], v[80:95]
    v_exp_f32 v105, v73
    v_exp_f32 v106, v74
    v_exp_f32 v107, v75
    v_mfma_f32_32x32x16_bf16 v[80:95], v[224:227], v[196:199], v[80:95]
    v_exp_f32 v108, v76
    v_exp_f32 v109, v77
    v_exp_f32 v110, v78
    v_exp_f32 v111, v79
    v_pk_fma_f32 v[228:229], v[112:113], v[96:97], v[112:113]
    v_pk_fma_f32 v[112:113], v[64:65], v[120:121], v[228:229]
    v_pk_fma_f32 v[120:121], v[120:121], v[96:97], v[120:121]
    v_pk_fma_f32 v[228:229], v[112:113], v[98:99], v[112:113]
    v_pk_fma_f32 v[112:113], v[66:67], v[120:121], v[228:229]
    v_pk_fma_f32 v[120:121], v[120:121], v[98:99], v[120:121]
    v_pk_fma_f32 v[228:229], v[112:113], v[100:101], v[112:113]
    v_pk_fma_f32 v[112:113], v[68:69], v[120:121], v[228:229]
    v_pk_fma_f32 v[120:121], v[120:121], v[100:101], v[120:121]
    v_pk_fma_f32 v[228:229], v[112:113], v[102:103], v[112:113]
    v_pk_fma_f32 v[112:113], v[70:71], v[120:121], v[228:229]
    v_pk_fma_f32 v[120:121], v[120:121], v[102:103], v[120:121]
    v_rcp_f32 v36, v120
    v_rcp_f32 v37, v121
    v_pk_mul_f32 v[38:39], v[120:121], 0 op_sel_hi:[1,0]
    v_pk_fma_f32 v[38:39], v[112:113], v[36:37], v[38:39]
    v_pk_add_f32 v[120:121], v[104:105], 1.0 op_sel_hi:[1,0]
    v_add_f32 v32, v38, v39
    v_pk_fma_f32 v[228:229], v[72:73], v[106:107], v[72:73]
    v_pk_fma_f32 v[112:113], v[74:75], v[120:121], v[228:229]
    v_pk_fma_f32 v[120:121], v[120:121], v[106:107], v[120:121]
    v_pk_fma_f32 v[228:229], v[112:113], v[108:109], v[112:113]
    v_pk_fma_f32 v[112:113], v[76:77], v[120:121], v[228:229]
    v_pk_fma_f32 v[120:121], v[120:121], v[108:109], v[120:121]
    v_pk_fma_f32 v[228:229], v[112:113], v[110:111], v[112:113]
    v_pk_fma_f32 v[112:113], v[78:79], v[120:121], v[228:229]
    v_pk_fma_f32 v[120:121], v[120:121], v[110:111], v[120:121]
    v_mfma_f32_32x32x16_bf16 v[64:79], v[208:211], v[136:139], 0
    v_exp_f32 v96, v80
    v_exp_f32 v97, v81
    v_exp_f32 v98, v82
    v_mfma_f32_32x32x16_bf16 v[64:79], v[212:215], v[152:155], v[64:79]
    v_exp_f32 v99, v83
    v_exp_f32 v100, v84
    v_exp_f32 v101, v85
    v_mfma_f32_32x32x16_bf16 v[64:79], v[216:219], v[168:171], v[64:79]
    v_exp_f32 v102, v86
    v_exp_f32 v103, v87
    v_exp_f32 v104, v88
    v_mfma_f32_32x32x16_bf16 v[64:79], v[220:223], v[184:187], v[64:79]
    v_exp_f32 v105, v89
    v_exp_f32 v106, v90
    v_exp_f32 v107, v91
    v_mfma_f32_32x32x16_bf16 v[64:79], v[224:227], v[200:203], v[64:79]
    v_exp_f32 v108, v92
    v_exp_f32 v109, v93
    v_exp_f32 v110, v94
    v_exp_f32 v111, v95
    v_add_u32_sdwa v248, s76, v243 dst_sel:DWORD dst_unused:UNUSED_PAD src0_sel:WORD_0 src1_sel:DWORD
    ds_read_b32 v230, v248 offset:0
    ds_read_b32 v232, v248 offset:128
    ds_read_b32 v234, v248 offset:256
    ds_read_b32 v236, v248 offset:384
    v_pk_fma_f32 v[228:229], v[114:115], v[96:97], v[114:115]
    v_pk_fma_f32 v[114:115], v[80:81], v[122:123], v[228:229]
    v_pk_fma_f32 v[122:123], v[122:123], v[96:97], v[122:123]
    v_pk_fma_f32 v[228:229], v[114:115], v[98:99], v[114:115]
    v_pk_fma_f32 v[114:115], v[82:83], v[122:123], v[228:229]
    v_pk_fma_f32 v[122:123], v[122:123], v[98:99], v[122:123]
    v_pk_fma_f32 v[228:229], v[114:115], v[100:101], v[114:115]
    v_pk_fma_f32 v[114:115], v[84:85], v[122:123], v[228:229]
    v_pk_fma_f32 v[122:123], v[122:123], v[100:101], v[122:123]
    v_pk_fma_f32 v[228:229], v[114:115], v[102:103], v[114:115]
    v_pk_fma_f32 v[114:115], v[86:87], v[122:123], v[228:229]
    v_pk_fma_f32 v[122:123], v[122:123], v[102:103], v[122:123]
    v_rcp_f32 v36, v122
    v_rcp_f32 v37, v123
    v_pk_mul_f32 v[38:39], v[122:123], 0 op_sel_hi:[1,0]
    v_pk_fma_f32 v[38:39], v[114:115], v[36:37], v[38:39]
    v_pk_add_f32 v[122:123], v[104:105], 1.0 op_sel_hi:[1,0]
    v_add_f32 v33, v38, v39
    v_pk_fma_f32 v[228:229], v[88:89], v[106:107], v[88:89]
    v_pk_fma_f32 v[114:115], v[90:91], v[122:123], v[228:229]
    v_pk_fma_f32 v[122:123], v[122:123], v[106:107], v[122:123]
    v_pk_fma_f32 v[228:229], v[114:115], v[108:109], v[114:115]
    v_pk_fma_f32 v[114:115], v[92:93], v[122:123], v[228:229]
    v_pk_fma_f32 v[122:123], v[122:123], v[108:109], v[122:123]
    v_pk_fma_f32 v[228:229], v[114:115], v[110:111], v[114:115]
    v_pk_fma_f32 v[114:115], v[94:95], v[122:123], v[228:229]
    v_pk_fma_f32 v[122:123], v[122:123], v[110:111], v[122:123]
    v_mfma_f32_32x32x16_bf16 v[80:95], v[208:211], v[140:143], 0
    v_exp_f32 v96, v64
    v_exp_f32 v97, v65
    v_exp_f32 v98, v66
    v_mfma_f32_32x32x16_bf16 v[80:95], v[212:215], v[156:159], v[80:95]
    v_exp_f32 v99, v67
    v_exp_f32 v100, v68
    v_exp_f32 v101, v69
    v_mfma_f32_32x32x16_bf16 v[80:95], v[216:219], v[172:175], v[80:95]
    v_exp_f32 v102, v70
    v_exp_f32 v103, v71
    v_exp_f32 v104, v72
    v_mfma_f32_32x32x16_bf16 v[80:95], v[220:223], v[188:191], v[80:95]
    v_exp_f32 v105, v73
    v_exp_f32 v106, v74
    v_exp_f32 v107, v75
    v_mfma_f32_32x32x16_bf16 v[80:95], v[224:227], v[204:207], v[80:95]
    v_exp_f32 v108, v76
    v_exp_f32 v109, v77
    v_exp_f32 v110, v78
    v_exp_f32 v111, v79
    s_waitcnt vmcnt(0)
    ds_read_b128 v[208:211], v238
    ds_read_b128 v[212:215], v239
    ds_read_b128 v[216:219], v240
    ds_read_b128 v[220:223], v241
    v_add_u32_sdwa v249, s74, v242 dst_sel:DWORD dst_unused:UNUSED_PAD src0_sel:WORD_0 src1_sel:DWORD
    ds_read_b128 v[224:227], v249
    s_bitcmp1_b32 s75, 5
    s_cbranch_scc0 NQR_b4
    s_and_b32 s81, s75, 0xfe00fe00
    v_add_u32_sdwa v250, s81, v244 dst_sel:DWORD dst_unused:UNUSED_PAD src0_sel:WORD_0 src1_sel:DWORD
    v_add_u32_sdwa v40, s81, v244 dst_sel:DWORD dst_unused:UNUSED_PAD src0_sel:WORD_1 src1_sel:DWORD
    ds_read2_b32 v[44:45], v250 offset0:0 offset1:32
    ds_read2_b32 v[48:49], v40 offset0:0 offset1:32
    ds_read2_b32 v[46:47], v250 offset0:64 offset1:96
    ds_read2_b32 v[50:51], v40 offset0:64 offset1:96
NQR_b4:
    v_pk_fma_f32 v[228:229], v[116:117], v[96:97], v[116:117]
    v_pk_fma_f32 v[116:117], v[64:65], v[124:125], v[228:229]
    v_pk_fma_f32 v[124:125], v[124:125], v[96:97], v[124:125]
    v_pk_fma_f32 v[228:229], v[116:117], v[98:99], v[116:117]
    v_pk_fma_f32 v[116:117], v[66:67], v[124:125], v[228:229]
    v_pk_fma_f32 v[124:125], v[124:125], v[98:99], v[124:125]
    v_pk_fma_f32 v[228:229], v[116:117], v[100:101], v[116:117]
    v_pk_fma_f32 v[116:117], v[68:69], v[124:125], v[228:229]
    v_pk_fma_f32 v[124:125], v[124:125], v[100:101], v[124:125]
    v_pk_fma_f32 v[228:229], v[116:117], v[102:103], v[116:117]
    v_pk_fma_f32 v[116:117], v[70:71], v[124:125], v[228:229]
    v_pk_fma_f32 v[124:125], v[124:125], v[102:103], v[124:125]
    v_rcp_f32 v36, v124
    v_rcp_f32 v37, v125
    v_pk_mul_f32 v[38:39], v[124:125], 0 op_sel_hi:[1,0]
    v_pk_fma_f32 v[38:39], v[116:117], v[36:37], v[38:39]
    v_pk_add_f32 v[124:125], v[104:105], 1.0 op_sel_hi:[1,0]
    v_add_f32 v34, v38, v39
    v_pk_fma_f32 v[228:229], v[72:73], v[106:107], v[72:73]
    v_pk_fma_f32 v[116:117], v[74:75], v[124:125], v[228:229]
    v_pk_fma_f32 v[124:125], v[124:125], v[106:107], v[124:125]
    v_pk_fma_f32 v[228:229], v[116:117], v[108:109], v[116:117]
    v_pk_fma_f32 v[116:117], v[76:77], v[124:125], v[228:229]
    v_pk_fma_f32 v[124:125], v[124:125], v[108:109], v[124:125]
    v_pk_fma_f32 v[228:229], v[116:117], v[110:111], v[116:117]
    v_pk_fma_f32 v[116:117], v[78:79], v[124:125], v[228:229]
    v_pk_fma_f32 v[124:125], v[124:125], v[110:111], v[124:125]
    s_waitcnt lgkmcnt(0)
    s_bitcmp1_b32 s75, 5
    s_cbranch_scc0 NQM_b4
    v_perm_b32 v195, v48, v44, v41
    v_perm_b32 v199, v49, v45, v41
    v_perm_b32 v203, v50, v46, v41
    v_perm_b32 v207, v51, v47, v41
NQM_b4:
    v_mfma_f32_32x32x16_bf16 v[64:79], v[208:211], v[128:131], 0
    v_exp_f32 v96, v80
    v_exp_f32 v97, v81
    v_exp_f32 v98, v82
    v_mfma_f32_32x32x16_bf16 v[64:79], v[212:215], v[144:147], v[64:79]
    v_exp_f32 v99, v83
    v_exp_f32 v100, v84
    v_exp_f32 v101, v85
    v_mfma_f32_32x32x16_bf16 v[64:79], v[216:219], v[160:163], v[64:79]
    v_exp_f32 v102, v86
    v_exp_f32 v103, v87
    v_exp_f32 v104, v88
    v_mfma_f32_32x32x16_bf16 v[64:79], v[220:223], v[176:179], v[64:79]
    v_exp_f32 v105, v89
    v_exp_f32 v106, v90
    v_exp_f32 v107, v91
    v_mfma_f32_32x32x16_bf16 v[64:79], v[224:227], v[192:195], v[64:79]
    v_exp_f32 v108, v92
    v_exp_f32 v109, v93
    v_exp_f32 v110, v94
    v_exp_f32 v111, v95
    buffer_load_dwordx4 v[230:231], s[12:15], 0 idxen offen offset:0 lds
    buffer_load_dwordx4 v[232:233], s[12:15], 0 idxen offen offset:1024 lds
    buffer_load_dwordx4 v[234:235], s[12:15], 0 idxen offen offset:2048 lds
    buffer_load_dwordx4 v[236:237], s[12:15], 0 idxen offen offset:3072 lds
    v_add_u32_sdwa v251, s72, v246 dst_sel:DWORD dst_unused:UNUSED_PAD src0_sel:WORD_1 src1_sel:DWORD
    ds_read2st64_b32 v[252:253], v251 offset0:0 offset1:1
    v_pk_fma_f32 v[228:229], v[118:119], v[96:97], v[118:119]
    v_pk_fma_f32 v[118:119], v[80:81], v[126:127], v[228:229]
    v_pk_fma_f32 v[126:127], v[126:127], v[96:97], v[126:127]
    v_pk_fma_f32 v[228:229], v[118:119], v[98:99], v[118:119]
    v_pk_fma_f32 v[118:119], v[82:83], v[126:127], v[228:229]
    v_pk_fma_f32 v[126:127], v[126:127], v[98:99], v[126:127]
    v_pk_fma_f32 v[228:229], v[118:119], v[100:101], v[118:119]
    v_pk_fma_f32 v[118:119], v[84:85], v[126:127], v[228:229]
    v_pk_fma_f32 v[126:127], v[126:127], v[100:101], v[126:127]
    v_pk_fma_f32 v[228:229], v[118:119], v[102:103], v[118:119]
    v_pk_fma_f32 v[118:119], v[86:87], v[126:127], v[228:229]
    v_pk_fma_f32 v[126:127], v[126:127], v[102:103], v[126:127]
    v_rcp_f32 v36, v126
    v_rcp_f32 v37, v127
    v_pk_mul_f32 v[38:39], v[126:127], 0 op_sel_hi:[1,0]
    v_pk_fma_f32 v[38:39], v[118:119], v[36:37], v[38:39]
    v_pk_add_f32 v[126:127], v[104:105], 1.0 op_sel_hi:[1,0]
    v_add_f32 v35, v38, v39
    v_pk_fma_f32 v[228:229], v[88:89], v[106:107], v[88:89]
    v_pk_fma_f32 v[118:119], v[90:91], v[126:127], v[228:229]
    v_pk_fma_f32 v[126:127], v[126:127], v[106:107], v[126:127]
    v_pk_fma_f32 v[228:229], v[118:119], v[108:109], v[118:119]
    v_pk_fma_f32 v[118:119], v[92:93], v[126:127], v[228:229]
    v_pk_fma_f32 v[126:127], v[126:127], v[108:109], v[126:127]
    v_pk_fma_f32 v[228:229], v[118:119], v[110:111], v[118:119]
    v_pk_fma_f32 v[118:119], v[94:95], v[126:127], v[228:229]
    v_pk_fma_f32 v[126:127], v[126:127], v[110:111], v[126:127]
    s_nop 1
    v_permlane32_swap_b32 v32, v33
    v_permlane32_swap_b32 v34, v35
    v_add_f32 v32, v32, v33
    v_add_f32 v34, v34, v35
    s_waitcnt lgkmcnt(0)
    v_add_f32 v32, v32, v252
    v_add_f32 v34, v34, v253
    ds_write2st64_b32 v251, v32, v34 offset0:0 offset1:1
    s_cmp_lt_u32 s101, s95
    s_cbranch_scc1 NP_b4
    s_setprio 0
NP_b4:
    s_bitcmp1_b32 s73, 4
    s_cbranch_scc1 FLUSHB
    s_mov_b64 s[72:73], s[74:75]
    s_mov_b64 s[74:75], s[76:77]
    v_readlane_b32 s76, v247, s101
    v_readlane_b32 s77, v245, s101
    s_add_u32 s101, s101, 1
    s_and_b32 s84, s73, 15
    s_mul_i32 s85, s84, s3
    s_add_u32 s90, s10, s85
    s_addc_u32 s91, s11, 0
    s_setpc_b64 s[90:91]
.p2align 11
BT5:
    v_mfma_f32_32x32x16_bf16 v[80:95], v[208:211], v[132:135], 0
    v_exp_f32 v96, v64
    v_exp_f32 v97, v65
    v_exp_f32 v98, v66
    v_mfma_f32_32x32x16_bf16 v[80:95], v[212:215], v[148:151], v[80:95]
    v_exp_f32 v99, v67
    v_exp_f32 v100, v68
    v_exp_f32 v101, v69
    v_mfma_f32_32x32x16_bf16 v[80:95], v[216:219], v[164:167], v[80:95]
    v_exp_f32 v102, v70
    v_exp_f32 v103, v71
    v_exp_f32 v104, v72
    v_mfma_f32_32x32x16_bf16 v[80:95], v[220:223], v[180:183], v[80:95]
    v_exp_f32 v105, v73
    v_exp_f32 v106, v74
    v_exp_f32 v107, v75
    v_mfma_f32_32x32x16_bf16 v[80:95], v[224:227], v[196:199], v[80:95]
    v_exp_f32 v108, v76
    v_exp_f32 v109, v77
    v_exp_f32 v110, v78
    v_exp_f32 v111, v79
    v_pk_fma_f32 v[228:229], v[112:113], v[96:97], v[112:113]
    v_pk_fma_f32 v[112:113], v[64:65], v[120:121], v[228:229]
    v_pk_fma_f32 v[120:121], v[120:121], v[96:97], v[120:121]
    v_pk_fma_f32 v[228:229], v[112:113], v[98:99], v[112:113]
    v_pk_fma_f32 v[112:113], v[66:67], v[120:121], v[228:229]
    v_pk_fma_f32 v[120:121], v[120:121], v[98:99], v[120:121]
    v_pk_fma_f32 v[228:229], v[112:113], v[100:101], v[112:113]
    v_pk_fma_f32 v[112:113], v[68:69], v[120:121], v[228:229]
    v_pk_fma_f32 v[120:121], v[120:121], v[100:101], v[120:121]
    v_pk_fma_f32 v[228:229], v[112:113], v[102:103], v[112:113]
    v_pk_fma_f32 v[112:113], v[70:71], v[120:121], v[228:229]
    v_pk_fma_f32 v[120:121], v[120:121], v[102:103], v[120:121]
    v_pk_fma_f32 v[228:229], v[112:113], v[104:105], v[112:113]
    v_pk_fma_f32 v[112:113], v[72:73], v[120:121], v[228:229]
    v_pk_fma_f32 v[120:121], v[120:121], v[104:105], v[120:121]
    v_rcp_f32 v36, v120
    v_rcp_f32 v37, v121
    v_pk_mul_f32 v[38:39], v[120:121], 0 op_sel_hi:[1,0]
    v_pk_fma_f32 v[38:39], v[112:113], v[36:37], v[38:39]
    v_pk_add_f32 v[120:121], v[106:107], 1.0 op_sel_hi:[1,0]
    v_add_f32 v32, v38, v39
    v_pk_fma_f32 v[228:229], v[74:75], v[108:109], v[74:75]
    v_pk_fma_f32 v[112:113], v[76:77], v[120:121], v[228:229]
    v_pk_fma_f32 v[120:121], v[120:121], v[108:109], v[120:121]
    v_pk_fma_f32 v[228:229], v[112:113], v[110:111], v[112:113]
    v_pk_fma_f32 v[112:113], v[78:79], v[120:121], v[228:229]
    v_pk_fma_f32 v[120:121], v[120:121], v[110:111], v[120:121]
    v_mfma_f32_32x32x16_bf16 v[64:79], v[208:211], v[136:139], 0
    v_exp_f32 v96, v80
    v_exp_f32 v97, v81
    v_exp_f32 v98, v82
    v_mfma_f32_32x32x16_bf16 v[64:79], v[212:215], v[152:155], v[64:79]
    v_exp_f32 v99, v83
    v_exp_f32 v100, v84
    v_exp_f32 v101, v85
    v_mfma_f32_32x32x16_bf16 v[64:79], v[216:219], v[168:171], v[64:79]
    v_exp_f32 v102, v86
    v_exp_f32 v103, v87
    v_exp_f32 v104, v88
    v_mfma_f32_32x32x16_bf16 v[64:79], v[220:223], v[184:187], v[64:79]
    v_exp_f32 v105, v89
    v_exp_f32 v106, v90
    v_exp_f32 v107, v91
    v_mfma_f32_32x32x16_bf16 v[64:79], v[224:227], v[200:203], v[64:79]
    v_exp_f32 v108, v92
    v_exp_f32 v109, v93
    v_exp_f32 v110, v94
    v_exp_f32 v111, v95
    v_add_u32_sdwa v248, s76, v243 dst_sel:DWORD dst_unused:UNUSED_PAD src0_sel:WORD_0 src1_sel:DWORD
    ds_read_b32 v230, v248 offset:0
    ds_read_b32 v232, v248 offset:128
    ds_read_b32 v234, v248 offset:256
    ds_read_b32 v236, v248 offset:384
    v_pk_fma_f32 v[228:229], v[114:115], v[96:97], v[114:115]
    v_pk_fma_f32 v[114:115], v[80:81], v[122:123], v[228:229]
    v_pk_fma_f32 v[122:123], v[122:123], v[96:97], v[122:123]
    v_pk_fma_f32 v[228:229], v[114:115], v[98:99], v[114:115]
    v_pk_fma_f32 v[114:115], v[82:83], v[122:123], v[228:229]
    v_pk_fma_f32 v[122:123], v[122:123], v[98:99], v[122:123]
    v_pk_fma_f32 v[228:229], v[114:115], v[100:101], v[114:115]
    v_pk_fma_f32 v[114:115], v[84:85], v[122:123], v[228:229]
    v_pk_fma_f32 v[122:123], v[122:123], v[100:101], v[122:123]
    v_pk_fma_f32 v[228:229], v[114:115], v[102:103], v[114:115]
    v_pk_fma_f32 v[114:115], v[86:87], v[122:123], v[228:229]
    v_pk_fma_f32 v[122:123], v[122:123], v[102:103], v[122:123]
    v_pk_fma_f32 v[228:229], v[114:115], v[104:105], v[114:115]
    v_pk_fma_f32 v[114:115], v[88:89], v[122:123], v[228:229]
    v_pk_fma_f32 v[122:123], v[122:123], v[104:105], v[122:123]
    v_rcp_f32 v36, v122
    v_rcp_f32 v37, v123
    v_pk_mul_f32 v[38:39], v[122:123], 0 op_sel_hi:[1,0]
    v_pk_fma_f32 v[38:39], v[114:115], v[36:37], v[38:39]
    v_pk_add_f32 v[122:123], v[106:107], 1.0 op_sel_hi:[1,0]
    v_add_f32 v33, v38, v39
    v_pk_fma_f32 v[228:229], v[90:91], v[108:109], v[90:91]
    v_pk_fma_f32 v[114:115], v[92:93], v[122:123], v[228:229]
    v_pk_fma_f32 v[122:123], v[122:123], v[108:109], v[122:123]
    v_pk_fma_f32 v[228:229], v[114:115], v[110:111], v[114:115]
    v_pk_fma_f32 v[114:115], v[94:95], v[122:123], v[228:229]
    v_pk_fma_f32 v[122:123], v[122:123], v[110:111], v[122:123]
    v_mfma_f32_32x32x16_bf16 v[80:95], v[208:211], v[140:143], 0
    v_exp_f32 v96, v64
    v_exp_f32 v97, v65
    v_exp_f32 v98, v66
    v_mfma_f32_32x32x16_bf16 v[80:95], v[212:215], v[156:159], v[80:95]
    v_exp_f32 v99, v67
    v_exp_f32 v100, v68
    v_exp_f32 v101, v69
    v_mfma_f32_32x32x16_bf16 v[80:95], v[216:219], v[172:175], v[80:95]
    v_exp_f32 v102, v70
    v_exp_f32 v103, v71
    v_exp_f32 v104, v72
    v_mfma_f32_32x32x16_bf16 v[80:95], v[220:223], v[188:191], v[80:95]
    v_exp_f32 v105, v73
    v_exp_f32 v106, v74
    v_exp_f32 v107, v75
    v_mfma_f32_32x32x16_bf16 v[80:95], v[224:227], v[204:207], v[80:95]
    v_exp_f32 v108, v76
    v_exp_f32 v109, v77
    v_exp_f32 v110, v78
    v_exp_f32 v111, v79
    s_waitcnt vmcnt(0)
    ds_read_b128 v[208:211], v238
    ds_read_b128 v[212:215], v239
    ds_read_b128 v[216:219], v240
    ds_read_b128 v[220:223], v241
    v_add_u32_sdwa v249, s74, v242 dst_sel:DWORD dst_unused:UNUSED_PAD src0_sel:WORD_0 src1_sel:DWORD
    ds_read_b128 v[224:227], v249
    s_bitcmp1_b32 s75, 5
    s_cbranch_scc0 NQR_b5
    s_and_b32 s81, s75, 0xfe00fe00
    v_add_u32_sdwa v250, s81, v244 dst_sel:DWORD dst_unused:UNUSED_PAD src0_sel:WORD_0 src1_sel:DWORD
    v_add_u32_sdwa v40, s81, v244 dst_sel:DWORD dst_unused:UNUSED_PAD src0_sel:WORD_1 src1_sel:DWORD
    ds_read2_b32 v[44:45], v250 offset0:0 offset1:32
    ds_read2_b32 v[48:49], v40 offset0:0 offset1:32
    ds_read2_b32 v[46:47], v250 offset0:64 offset1:96
    ds_read2_b32 v[50:51], v40 offset0:64 offset1:96
NQR_b5:
    v_pk_fma_f32 v[228:229], v[116:117], v[96:97], v[116:117]
    v_pk_fma_f32 v[116:117], v[64:65], v[124:125], v[228:229]
    v_pk_fma_f32 v[124:125], v[124:125], v[96:97], v[124:125]
    v_pk_fma_f32 v[228:229], v[116:117], v[98:99], v[116:117]
    v_pk_fma_f32 v[116:117], v[66:67], v[124:125], v[228:229]
    v_pk_fma_f32 v[124:125], v[124:125], v[98:99], v[124:125]
    v_pk_fma_f32 v[228:229], v[116:117], v[100:101], v[116:117]
    v_pk_fma_f32 v[116:117], v[68:69], v[124:125], v[228:229]
    v_pk_fma_f32 v[124:125], v[124:125], v[100:101], v[124:125]
    v_pk_fma_f32 v[228:229], v[116:117], v[102:103], v[116:117]
    v_pk_fma_f32 v[116:117], v[70:71], v[124:125], v[228:229]
    v_pk_fma_f32 v[124:125], v[124:125], v[102:103], v[124:125]
    v_pk_fma_f32 v[228:229], v[116:117], v[104:105], v[116:117]
    v_pk_fma_f32 v[116:117], v[72:73], v[124:125], v[228:229]
    v_pk_fma_f32 v[124:125], v[124:125], v[104:105], v[124:125]
    v_rcp_f32 v36, v124
    v_rcp_f32 v37, v125
    v_pk_mul_f32 v[38:39], v[124:125], 0 op_sel_hi:[1,0]
    v_pk_fma_f32 v[38:39], v[116:117], v[36:37], v[38:39]
    v_pk_add_f32 v[124:125], v[106:107], 1.0 op_sel_hi:[1,0]
    v_add_f32 v34, v38, v39
    v_pk_fma_f32 v[228:229], v[74:75], v[108:109], v[74:75]
    v_pk_fma_f32 v[116:117], v[76:77], v[124:125], v[228:229]
    v_pk_fma_f32 v[124:125], v[124:125], v[108:109], v[124:125]
    v_pk_fma_f32 v[228:229], v[116:117], v[110:111], v[116:117]
    v_pk_fma_f32 v[116:117], v[78:79], v[124:125], v[228:229]
    v_pk_fma_f32 v[124:125], v[124:125], v[110:111], v[124:125]
    s_waitcnt lgkmcnt(0)
    s_bitcmp1_b32 s75, 5
    s_cbranch_scc0 NQM_b5
    v_perm_b32 v195, v48, v44, v41
    v_perm_b32 v199, v49, v45, v41
    v_perm_b32 v203, v50, v46, v41
    v_perm_b32 v207, v51, v47, v41
NQM_b5:
    v_mfma_f32_32x32x16_bf16 v[64:79], v[208:211], v[128:131], 0
    v_exp_f32 v96, v80
    v_exp_f32 v97, v81
    v_exp_f32 v98, v82
    v_mfma_f32_32x32x16_bf16 v[64:79], v[212:215], v[144:147], v[64:79]
    v_exp_f32 v99, v83
    v_exp_f32 v100, v84
    v_exp_f32 v101, v85
    v_mfma_f32_32x32x16_bf16 v[64:79], v[216:219], v[160:163], v[64:79]
    v_exp_f32 v102, v86
    v_exp_f32 v103, v87
    v_exp_f32 v104, v88
    v_mfma_f32_32x32x16_bf16 v[64:79], v[220:223], v[176:179], v[64:79]
    v_exp_f32 v105, v89
    v_exp_f32 v106, v90
    v_exp_f32 v107, v91
    v_mfma_f32_32x32x16_bf16 v[64:79], v[224:227], v[192:195], v[64:79]
    v_exp_f32 v108, v92
    v_exp_f32 v109, v93
    v_exp_f32 v110, v94
    v_exp_f32 v111, v95
    buffer_load_dwordx4 v[230:231], s[12:15], 0 idxen offen offset:0 lds
    buffer_load_dwordx4 v[232:233], s[12:15], 0 idxen offen offset:1024 lds
    buffer_load_dwordx4 v[234:235], s[12:15], 0 idxen offen offset:2048 lds
    buffer_load_dwordx4 v[236:237], s[12:15], 0 idxen offen offset:3072 lds
    v_add_u32_sdwa v251, s72, v246 dst_sel:DWORD dst_unused:UNUSED_PAD src0_sel:WORD_1 src1_sel:DWORD
    ds_read2st64_b32 v[252:253], v251 offset0:0 offset1:1
    v_pk_fma_f32 v[228:229], v[118:119], v[96:97], v[118:119]
    v_pk_fma_f32 v[118:119], v[80:81], v[126:127], v[228:229]
    v_pk_fma_f32 v[126:127], v[126:127], v[96:97], v[126:127]
    v_pk_fma_f32 v[228:229], v[118:119], v[98:99], v[118:119]
    v_pk_fma_f32 v[118:119], v[82:83], v[126:127], v[228:229]
    v_pk_fma_f32 v[126:127], v[126:127], v[98:99], v[126:127]
    v_pk_fma_f32 v[228:229], v[118:119], v[100:101], v[118:119]
    v_pk_fma_f32 v[118:119], v[84:85], v[126:127], v[228:229]
    v_pk_fma_f32 v[126:127], v[126:127], v[100:101], v[126:127]
    v_pk_fma_f32 v[228:229], v[118:119], v[102:103], v[118:119]
    v_pk_fma_f32 v[118:119], v[86:87], v[126:127], v[228:229]
    v_pk_fma_f32 v[126:127], v[126:127], v[102:103], v[126:127]
    v_pk_fma_f32 v[228:229], v[118:119], v[104:105], v[118:119]
    v_pk_fma_f32 v[118:119], v[88:89], v[126:127], v[228:229]
    v_pk_fma_f32 v[126:127], v[126:127], v[104:105], v[126:127]
    v_rcp_f32 v36, v126
    v_rcp_f32 v37, v127
    v_pk_mul_f32 v[38:39], v[126:127], 0 op_sel_hi:[1,0]
    v_pk_fma_f32 v[38:39], v[118:119], v[36:37], v[38:39]
    v_pk_add_f32 v[126:127], v[106:107], 1.0 op_sel_hi:[1,0]
    v_add_f32 v35, v38, v39
    v_pk_fma_f32 v[228:229], v[90:91], v[108:109], v[90:91]
    v_pk_fma_f32 v[118:119], v[92:93], v[126:127], v[228:229]
    v_pk_fma_f32 v[126:127], v[126:127], v[108:109], v[126:127]
    v_pk_fma_f32 v[228:229], v[118:119], v[110:111], v[118:119]
    v_pk_fma_f32 v[118:119], v[94:95], v[126:127], v[228:229]
    v_pk_fma_f32 v[126:127], v[126:127], v[110:111], v[126:127]
    s_nop 1
    v_permlane32_swap_b32 v32, v33
    v_permlane32_swap_b32 v34, v35
    v_add_f32 v32, v32, v33
    v_add_f32 v34, v34, v35
    s_waitcnt lgkmcnt(0)
    v_add_f32 v32, v32, v252
    v_add_f32 v34, v34, v253
    ds_write2st64_b32 v251, v32, v34 offset0:0 offset1:1
    s_cmp_lt_u32 s101, s95
    s_cbranch_scc1 NP_b5
    s_setprio 0
NP_b5:
    s_bitcmp1_b32 s73, 4
    s_cbranch_scc1 FLUSHB
    s_mov_b64 s[72:73], s[74:75]
    s_mov_b64 s[74:75], s[76:77]
    v_readlane_b32 s76, v247, s101
    v_readlane_b32 s77, v245, s101
    s_add_u32 s101, s101, 1
    s_and_b32 s84, s73, 15
    s_mul_i32 s85, s84, s3
    s_add_u32 s90, s10, s85
    s_addc_u32 s91, s11, 0
    s_setpc_b64 s[90:91]
.p2align 11
BT6:
    v_mfma_f32_32x32x16_bf16 v[80:95], v[208:211], v[132:135], 0
    v_exp_f32 v96, v64
    v_exp_f32 v97, v65
    v_exp_f32 v98, v66
    v_mfma_f32_32x32x16_bf16 v[80:95], v[212:215], v[148:151], v[80:95]
    v_exp_f32 v99, v67
    v_exp_f32 v100, v68
    v_exp_f32 v101, v69
    v_mfma_f32_32x32x16_bf16 v[80:95], v[216:219], v[164:167], v[80:95]
    v_exp_f32 v102, v70
    v_exp_f32 v103, v71
    v_exp_f32 v104, v72
    v_mfma_f32_32x32x16_bf16 v[80:95], v[220:223], v[180:183], v[80:95]
    v_exp_f32 v105, v73
    v_exp_f32 v106, v74
    v_exp_f32 v107, v75
    v_mfma_f32_32x32x16_bf16 v[80:95], v[224:227], v[196:199], v[80:95]
    v_exp_f32 v108, v76
    v_exp_f32 v109, v77
    v_exp_f32 v110, v78
    v_exp_f32 v111, v79
    v_pk_fma_f32 v[228:229], v[112:113], v[96:97], v[112:113]
    v_pk_fma_f32 v[112:113], v[64:65], v[120:121], v[228:229]
    v_pk_fma_f32 v[120:121], v[120:121], v[96:97], v[120:121]
    v_pk_fma_f32 v[228:229], v[112:113], v[98:99], v[112:113]
    v_pk_fma_f32 v[112:113], v[66:67], v[120:121], v[228:229]
    v_pk_fma_f32 v[120:121], v[120:121], v[98:99], v[120:121]
    v_pk_fma_f32 v[228:229], v[112:113], v[100:101], v[112:113]
    v_pk_fma_f32 v[112:113], v[68:69], v[120:121], v[228:229]
    v_pk_fma_f32 v[120:121], v[120:121], v[100:101], v[120:121]
    v_pk_fma_f32 v[228:229], v[112:113], v[102:103], v[112:113]
    v_pk_fma_f32 v[112:113], v[70:71], v[120:121], v[228:229]
    v_pk_fma_f32 v[120:121], v[120:121], v[102:103], v[120:121]
    v_pk_fma_f32 v[228:229], v[112:113], v[104:105], v[112:113]
    v_pk_fma_f32 v[112:113], v[72:73], v[120:121], v[228:229]
    v_pk_fma_f32 v[120:121], v[120:121], v[104:105], v[120:121]
    v_pk_fma_f32 v[228:229], v[112:113], v[106:107], v[112:113]
    v_pk_fma_f32 v[112:113], v[74:75], v[120:121], v[228:229]
    v_pk_fma_f32 v[120:121], v[120:121], v[106:107], v[120:121]
    v_rcp_f32 v36, v120
    v_rcp_f32 v37, v121
    v_pk_mul_f32 v[38:39], v[120:121], 0 op_sel_hi:[1,0]
    v_pk_fma_f32 v[38:39], v[112:113], v[36:37], v[38:39]
    v_pk_add_f32 v[120:121], v[108:109], 1.0 op_sel_hi:[1,0]
    v_add_f32 v32, v38, v39
    v_pk_fma_f32 v[228:229], v[76:77], v[110:111], v[76:77]
    v_pk_fma_f32 v[112:113], v[78:79], v[120:121], v[228:229]
    v_pk_fma_f32 v[120:121], v[120:121], v[110:111], v[120:121]
    v_mfma_f32_32x32x16_bf16 v[64:79], v[208:211], v[136:139], 0
    v_exp_f32 v96, v80
    v_exp_f32 v97, v81
    v_exp_f32 v98, v82
    v_mfma_f32_32x32x16_bf16 v[64:79], v[212:215], v[152:155], v[64:79]
    v_exp_f32 v99, v83
    v_exp_f32 v100, v84
    v_exp_f32 v101, v85
    v_mfma_f32_32x32x16_bf16 v[64:79], v[216:219], v[168:171], v[64:79]
    v_exp_f32 v102, v86
    v_exp_f32 v103, v87
    v_exp_f32 v104, v88
    v_mfma_f32_32x32x16_bf16 v[64:79], v[220:223], v[184:187], v[64:79]
    v_exp_f32 v105, v89
    v_exp_f32 v106, v90
    v_exp_f32 v107, v91
    v_mfma_f32_32x32x16_bf16 v[64:79], v[224:227], v[200:203], v[64:79]
    v_exp_f32 v108, v92
    v_exp_f32 v109, v93
    v_exp_f32 v110, v94
    v_exp_f32 v111, v95
    v_add_u32_sdwa v248, s76, v243 dst_sel:DWORD dst_unused:UNUSED_PAD src0_sel:WORD_0 src1_sel:DWORD
    ds_read_b32 v230, v248 offset:0
    ds_read_b32 v232, v248 offset:128
    ds_read_b32 v234, v248 offset:256
    ds_read_b32 v236, v248 offset:384
    v_pk_fma_f32 v[228:229], v[114:115], v[96:97], v[114:115]
    v_pk_fma_f32 v[114:115], v[80:81], v[122:123], v[228:229]
    v_pk_fma_f32 v[122:123], v[122:123], v[96:97], v[122:123]
    v_pk_fma_f32 v[228:229], v[114:115], v[98:99], v[114:115]
    v_pk_fma_f32 v[114:115], v[82:83], v[122:123], v[228:229]
    v_pk_fma_f32 v[122:123], v[122:123], v[98:99], v[122:123]
    v_pk_fma_f32 v[228:229], v[114:115], v[100:101], v[114:115]
    v_pk_fma_f32 v[114:115], v[84:85], v[122:123], v[228:229]
    v_pk_fma_f32 v[122:123], v[122:123], v[100:101], v[122:123]
    v_pk_fma_f32 v[228:229], v[114:115], v[102:103], v[114:115]
    v_pk_fma_f32 v[114:115], v[86:87], v[122:123], v[228:229]
    v_pk_fma_f32 v[122:123], v[122:123], v[102:103], v[122:123]
    v_pk_fma_f32 v[228:229], v[114:115], v[104:105], v[114:115]
    v_pk_fma_f32 v[114:115], v[88:89], v[122:123], v[228:229]
    v_pk_fma_f32 v[122:123], v[122:123], v[104:105], v[122:123]
    v_pk_fma_f32 v[228:229], v[114:115], v[106:107], v[114:115]
    v_pk_fma_f32 v[114:115], v[90:91], v[122:123], v[228:229]
    v_pk_fma_f32 v[122:123], v[122:123], v[106:107], v[122:123]
    v_rcp_f32 v36, v122
    v_rcp_f32 v37, v123
    v_pk_mul_f32 v[38:39], v[122:123], 0 op_sel_hi:[1,0]
    v_pk_fma_f32 v[38:39], v[114:115], v[36:37], v[38:39]
    v_pk_add_f32 v[122:123], v[108:109], 1.0 op_sel_hi:[1,0]
    v_add_f32 v33, v38, v39
    v_pk_fma_f32 v[228:229], v[92:93], v[110:111], v[92:93]
    v_pk_fma_f32 v[114:115], v[94:95], v[122:123], v[228:229]
    v_pk_fma_f32 v[122:123], v[122:123], v[110:111], v[122:123]
    v_mfma_f32_32x32x16_bf16 v[80:95], v[208:211], v[140:143], 0
    v_exp_f32 v96, v64
    v_exp_f32 v97, v65
    v_exp_f32 v98, v66
    v_mfma_f32_32x32x16_bf16 v[80:95], v[212:215], v[156:159], v[80:95]
    v_exp_f32 v99, v67
    v_exp_f32 v100, v68
    v_exp_f32 v101, v69
    v_mfma_f32_32x32x16_bf16 v[80:95], v[216:219], v[172:175], v[80:95]
    v_exp_f32 v102, v70
    v_exp_f32 v103, v71
    v_exp_f32 v104, v72
    v_mfma_f32_32x32x16_bf16 v[80:95], v[220:223], v[188:191], v[80:95]
    v_exp_f32 v105, v73
    v_exp_f32 v106, v74
    v_exp_f32 v107, v75
    v_mfma_f32_32x32x16_bf16 v[80:95], v[224:227], v[204:207], v[80:95]
    v_exp_f32 v108, v76
    v_exp_f32 v109, v77
    v_exp_f32 v110, v78
    v_exp_f32 v111, v79
    s_waitcnt vmcnt(0)
    ds_read_b128 v[208:211], v238
    ds_read_b128 v[212:215], v239
    ds_read_b128 v[216:219], v240
    ds_read_b128 v[220:223], v241
    v_add_u32_sdwa v249, s74, v242 dst_sel:DWORD dst_unused:UNUSED_PAD src0_sel:WORD_0 src1_sel:DWORD
    ds_read_b128 v[224:227], v249
    s_bitcmp1_b32 s75, 5
    s_cbranch_scc0 NQR_b6
    s_and_b32 s81, s75, 0xfe00fe00
    v_add_u32_sdwa v250, s81, v244 dst_sel:DWORD dst_unused:UNUSED_PAD src0_sel:WORD_0 src1_sel:DWORD
    v_add_u32_sdwa v40, s81, v244 dst_sel:DWORD dst_unused:UNUSED_PAD src0_sel:WORD_1 src1_sel:DWORD
    ds_read2_b32 v[44:45], v250 offset0:0 offset1:32
    ds_read2_b32 v[48:49], v40 offset0:0 offset1:32
    ds_read2_b32 v[46:47], v250 offset0:64 offset1:96
    ds_read2_b32 v[50:51], v40 offset0:64 offset1:96
NQR_b6:
    v_pk_fma_f32 v[228:229], v[116:117], v[96:97], v[116:117]
    v_pk_fma_f32 v[116:117], v[64:65], v[124:125], v[228:229]
    v_pk_fma_f32 v[124:125], v[124:125], v[96:97], v[124:125]
    v_pk_fma_f32 v[228:229], v[116:117], v[98:99], v[116:117]
    v_pk_fma_f32 v[116:117], v[66:67], v[124:125], v[228:229]
    v_pk_fma_f32 v[124:125], v[124:125], v[98:99], v[124:125]
    v_pk_fma_f32 v[228:229], v[116:117], v[100:101], v[116:117]
    v_pk_fma_f32 v[116:117], v[68:69], v[124:125], v[228:229]
    v_pk_fma_f32 v[124:125], v[124:125], v[100:101], v[124:125]
    v_pk_fma_f32 v[228:229], v[116:117], v[102:103], v[116:117]
    v_pk_fma_f32 v[116:117], v[70:71], v[124:125], v[228:229]
    v_pk_fma_f32 v[124:125], v[124:125], v[102:103], v[124:125]
    v_pk_fma_f32 v[228:229], v[116:117], v[104:105], v[116:117]
    v_pk_fma_f32 v[116:117], v[72:73], v[124:125], v[228:229]
    v_pk_fma_f32 v[124:125], v[124:125], v[104:105], v[124:125]
    v_pk_fma_f32 v[228:229], v[116:117], v[106:107], v[116:117]
    v_pk_fma_f32 v[116:117], v[74:75], v[124:125], v[228:229]
    v_pk_fma_f32 v[124:125], v[124:125], v[106:107], v[124:125]
    v_rcp_f32 v36, v124
    v_rcp_f32 v37, v125
    v_pk_mul_f32 v[38:39], v[124:125], 0 op_sel_hi:[1,0]
    v_pk_fma_f32 v[38:39], v[116:117], v[36:37], v[38:39]
    v_pk_add_f32 v[124:125], v[108:109], 1.0 op_sel_hi:[1,0]
    v_add_f32 v34, v38, v39
    v_pk_fma_f32 v[228:229], v[76:77], v[110:111], v[76:77]
    v_pk_fma_f32 v[116:117], v[78:79], v[124:125], v[228:229]
    v_pk_fma_f32 v[124:125], v[124:125], v[110:111], v[124:125]
    s_waitcnt lgkmcnt(0)
    s_bitcmp1_b32 s75, 5
    s_cbranch_scc0 NQM_b6
    v_perm_b32 v195, v48, v44, v41
    v_perm_b32 v199, v49, v45, v41
    v_perm_b32 v203, v50, v46, v41
    v_perm_b32 v207, v51, v47, v41
NQM_b6:
    v_mfma_f32_32x32x16_bf16 v[64:79], v[208:211], v[128:131], 0
    v_exp_f32 v96, v80
    v_exp_f32 v97, v81
    v_exp_f32 v98, v82
    v_mfma_f32_32x32x16_bf16 v[64:79], v[212:215], v[144:147], v[64:79]
    v_exp_f32 v99, v83
    v_exp_f32 v100, v84
    v_exp_f32 v101, v85
    v_mfma_f32_32x32x16_bf16 v[64:79], v[216:219], v[160:163], v[64:79]
    v_exp_f32 v102, v86
    v_exp_f32 v103, v87
    v_exp_f32 v104, v88
    v_mfma_f32_32x32x16_bf16 v[64:79], v[220:223], v[176:179], v[64:79]
    v_exp_f32 v105, v89
    v_exp_f32 v106, v90
    v_exp_f32 v107, v91
    v_mfma_f32_32x32x16_bf16 v[64:79], v[224:227], v[192:195], v[64:79]
    v_exp_f32 v108, v92
    v_exp_f32 v109, v93
    v_exp_f32 v110, v94
    v_exp_f32 v111, v95
    buffer_load_dwordx4 v[230:231], s[12:15], 0 idxen offen offset:0 lds
    buffer_load_dwordx4 v[232:233], s[12:15], 0 idxen offen offset:1024 lds
    buffer_load_dwordx4 v[234:235], s[12:15], 0 idxen offen offset:2048 lds
    buffer_load_dwordx4 v[236:237], s[12:15], 0 idxen offen offset:3072 lds
    v_add_u32_sdwa v251, s72, v246 dst_sel:DWORD dst_unused:UNUSED_PAD src0_sel:WORD_1 src1_sel:DWORD
    ds_read2st64_b32 v[252:253], v251 offset0:0 offset1:1
    v_pk_fma_f32 v[228:229], v[118:119], v[96:97], v[118:119]
    v_pk_fma_f32 v[118:119], v[80:81], v[126:127], v[228:229]
    v_pk_fma_f32 v[126:127], v[126:127], v[96:97], v[126:127]
    v_pk_fma_f32 v[228:229], v[118:119], v[98:99], v[118:119]
    v_pk_fma_f32 v[118:119], v[82:83], v[126:127], v[228:229]
    v_pk_fma_f32 v[126:127], v[126:127], v[98:99], v[126:127]
    v_pk_fma_f32 v[228:229], v[118:119], v[100:101], v[118:119]
    v_pk_fma_f32 v[118:119], v[84:85], v[126:127], v[228:229]
    v_pk_fma_f32 v[126:127], v[126:127], v[100:101], v[126:127]
    v_pk_fma_f32 v[228:229], v[118:119], v[102:103], v[118:119]
    v_pk_fma_f32 v[118:119], v[86:87], v[126:127], v[228:229]
    v_pk_fma_f32 v[126:127], v[126:127], v[102:103], v[126:127]
    v_pk_fma_f32 v[228:229], v[118:119], v[104:105], v[118:119]
    v_pk_fma_f32 v[118:119], v[88:89], v[126:127], v[228:229]
    v_pk_fma_f32 v[126:127], v[126:127], v[104:105], v[126:127]
    v_pk_fma_f32 v[228:229], v[118:119], v[106:107], v[118:119]
    v_pk_fma_f32 v[118:119], v[90:91], v[126:127], v[228:229]
    v_pk_fma_f32 v[126:127], v[126:127], v[106:107], v[126:127]
    v_rcp_f32 v36, v126
    v_rcp_f32 v37, v127
    v_pk_mul_f32 v[38:39], v[126:127], 0 op_sel_hi:[1,0]
    v_pk_fma_f32 v[38:39], v[118:119], v[36:37], v[38:39]
    v_pk_add_f32 v[126:127], v[108:109], 1.0 op_sel_hi:[1,0]
    v_add_f32 v35, v38, v39
    v_pk_fma_f32 v[228:229], v[92:93], v[110:111], v[92:93]
    v_pk_fma_f32 v[118:119], v[94:95], v[126:127], v[228:229]
    v_pk_fma_f32 v[126:127], v[126:127], v[110:111], v[126:127]
    s_nop 1
    v_permlane32_swap_b32 v32, v33
    v_permlane32_swap_b32 v34, v35
    v_add_f32 v32, v32, v33
    v_add_f32 v34, v34, v35
    s_waitcnt lgkmcnt(0)
    v_add_f32 v32, v32, v252
    v_add_f32 v34, v34, v253
    ds_write2st64_b32 v251, v32, v34 offset0:0 offset1:1
    s_cmp_lt_u32 s101, s95
    s_cbranch_scc1 NP_b6
    s_setprio 0
NP_b6:
    s_bitcmp1_b32 s73, 4
    s_cbranch_scc1 FLUSHB
    s_mov_b64 s[72:73], s[74:75]
    s_mov_b64 s[74:75], s[76:77]
    v_readlane_b32 s76, v247, s101
    v_readlane_b32 s77, v245, s101
    s_add_u32 s101, s101, 1
    s_and_b32 s84, s73, 15
    s_mul_i32 s85, s84, s3
    s_add_u32 s90, s10, s85
    s_addc_u32 s91, s11, 0
    s_setpc_b64 s[90:91]
.p2align 11
BT7:
    v_mfma_f32_32x32x16_bf16 v[80:95], v[208:211], v[132:135], 0
    v_exp_f32 v96, v64
    v_exp_f32 v97, v65
    v_exp_f32 v98, v66
    v_mfma_f32_32x32x16_bf16 v[80:95], v[212:215], v[148:151], v[80:95]
    v_exp_f32 v99, v67
    v_exp_f32 v100, v68
    v_exp_f32 v101, v69
    v_mfma_f32_32x32x16_bf16 v[80:95], v[216:219], v[164:167], v[80:95]
    v_exp_f32 v102, v70
    v_exp_f32 v103, v71
    v_exp_f32 v104, v72
    v_mfma_f32_32x32x16_bf16 v[80:95], v[220:223], v[180:183], v[80:95]
    v_exp_f32 v105, v73
    v_exp_f32 v106, v74
    v_exp_f32 v107, v75
    v_mfma_f32_32x32x16_bf16 v[80:95], v[224:227], v[196:199], v[80:95]
    v_exp_f32 v108, v76
    v_exp_f32 v109, v77
    v_exp_f32 v110, v78
    v_exp_f32 v111, v79
    v_pk_fma_f32 v[228:229], v[112:113], v[96:97], v[112:113]
    v_pk_fma_f32 v[112:113], v[64:65], v[120:121], v[228:229]
    v_pk_fma_f32 v[120:121], v[120:121], v[96:97], v[120:121]
    v_pk_fma_f32 v[228:229], v[112:113], v[98:99], v[112:113]
    v_pk_fma_f32 v[112:113], v[66:67], v[120:121], v[228:229]
    v_pk_fma_f32 v[120:121], v[120:121], v[98:99], v[120:121]
    v_pk_fma_f32 v[228:229], v[112:113], v[100:101], v[112:113]
    v_pk_fma_f32 v[112:113], v[68:69], v[120:121], v[228:229]
    v_pk_fma_f32 v[120:121], v[120:121], v[100:101], v[120:121]
    v_pk_fma_f32 v[228:229], v[112:113], v[102:103], v[112:113]
    v_pk_fma_f32 v[112:113], v[70:71], v[120:121], v[228:229]
    v_pk_fma_f32 v[120:121], v[120:121], v[102:103], v[120:121]
    v_pk_fma_f32 v[228:229], v[112:113], v[104:105], v[112:113]
    v_pk_fma_f32 v[112:113], v[72:73], v[120:121], v[228:229]
    v_pk_fma_f32 v[120:121], v[120:121], v[104:105], v[120:121]
    v_pk_fma_f32 v[228:229], v[112:113], v[106:107], v[112:113]
    v_pk_fma_f32 v[112:113], v[74:75], v[120:121], v[228:229]
    v_pk_fma_f32 v[120:121], v[120:121], v[106:107], v[120:121]
    v_pk_fma_f32 v[228:229], v[112:113], v[108:109], v[112:113]
    v_pk_fma_f32 v[112:113], v[76:77], v[120:121], v[228:229]
    v_pk_fma_f32 v[120:121], v[120:121], v[108:109], v[120:121]
    v_rcp_f32 v36, v120
    v_rcp_f32 v37, v121
    v_pk_mul_f32 v[38:39], v[120:121], 0 op_sel_hi:[1,0]
    v_pk_fma_f32 v[38:39], v[112:113], v[36:37], v[38:39]
    v_pk_add_f32 v[120:121], v[110:111], 1.0 op_sel_hi:[1,0]
    v_add_f32 v32, v38, v39
    v_mov_b32 v112, v78
    v_mov_b32 v113, v79
    v_mfma_f32_32x32x16_bf16 v[64:79], v[208:211], v[136:139], 0
    v_exp_f32 v96, v80
    v_exp_f32 v97, v81
    v_exp_f32 v98, v82
    v_mfma_f32_32x32x16_bf16 v[64:79], v[212:215], v[152:155], v[64:79]
    v_exp_f32 v99, v83
    v_exp_f32 v100, v84
    v_exp_f32 v101, v85
    v_mfma_f32_32x32x16_bf16 v[64:79], v[216:219], v[168:171], v[64:79]
    v_exp_f32 v102, v86
    v_exp_f32 v103, v87
    v_exp_f32 v104, v88
    v_mfma_f32_32x32x16_bf16 v[64:79], v[220:223], v[184:187], v[64:79]
    v_exp_f32 v105, v89
    v_exp_f32 v106, v90
    v_exp_f32 v107, v91
    v_mfma_f32_32x32x16_bf16 v[64:79], v[224:227], v[200:203], v[64:79]
    v_exp_f32 v108, v92
    v_exp_f32 v109, v93
    v_exp_f32 v110, v94
    v_exp_f32 v111, v95
    v_add_u32_sdwa v248, s76, v243 dst_sel:DWORD dst_unused:UNUSED_PAD src0_sel:WORD_0 src1_sel:DWORD
    ds_read_b32 v230, v248 offset:0
    ds_read_b32 v232, v248 offset:128
    ds_read_b32 v234, v248 offset:256
    ds_read_b32 v236, v248 offset:384
    v_pk_fma_f32 v[228:229], v[114:115], v[96:97], v[114:115]
    v_pk_fma_f32 v[114:115], v[80:81], v[122:123], v[228:229]
    v_pk_fma_f32 v[122:123], v[122:123], v[96:97], v[122:123]
    v_pk_fma_f32 v[228:229], v[114:115], v[98:99], v[114:115]
    v_pk_fma_f32 v[114:115], v[82:83], v[122:123], v[228:229]
    v_pk_fma_f32 v[122:123], v[122:123], v[98:99], v[122:123]
    v_pk_fma_f32 v[228:229], v[114:115], v[100:101], v[114:115]
    v_pk_fma_f32 v[114:115], v[84:85], v[122:123], v[228:229]
    v_pk_fma_f32 v[122:123], v[122:123], v[100:101], v[122:123]
    v_pk_fma_f32 v[228:229], v[114:115], v[102:103], v[114:115]
    v_pk_fma_f32 v[114:115], v[86:87], v[122:123], v[228:229]
    v_pk_fma_f32 v[122:123], v[122:123], v[102:103], v[122:123]
    v_pk_fma_f32 v[228:229], v[114:115], v[104:105], v[114:115]
    v_pk_fma_f32 v[114:115], v[88:89], v[122:123], v[228:229]
    v_pk_fma_f32 v[122:123], v[122:123], v[104:105], v[122:123]
    v_pk_fma_f32 v[228:229], v[114:115], v[106:107], v[114:115]
    v_pk_fma_f32 v[114:115], v[90:91], v[122:123], v[228:229]
    v_pk_fma_f32 v[122:123], v[122:123], v[106:107], v[122:123]
    v_pk_fma_f32 v[228:229], v[114:115], v[108:109], v[114:115]
    v_pk_fma_f32 v[114:115], v[92:93], v[122:123], v[228:229]
    v_pk_fma_f32 v[122:123], v[122:123], v[108:109], v[122:123]
    v_rcp_f32 v36, v122
    v_rcp_f32 v37, v123
    v_pk_mul_f32 v[38:39], v[122:123], 0 op_sel_hi:[1,0]
    v_pk_fma_f32 v[38:39], v[114:115], v[36:37], v[38:39]
    v_pk_add_f32 v[122:123], v[110:111], 1.0 op_sel_hi:[1,0]
    v_add_f32 v33, v38, v39
    v_mov_b32 v114, v94
    v_mov_b32 v115, v95
    v_mfma_f32_32x32x16_bf16 v[80:95], v[208:211], v[140:143], 0
    v_exp_f32 v96, v64
    v_exp_f32 v97, v65
    v_exp_f32 v98, v66
    v_mfma_f32_32x32x16_bf16 v[80:95], v[212:215], v[156:159], v[80:95]
    v_exp_f32 v99, v67
    v_exp_f32 v100, v68
    v_exp_f32 v101, v69
    v_mfma_f32_32x32x16_bf16 v[80:95], v[216:219], v[172:175], v[80:95]
    v_exp_f32 v102, v70
    v_exp_f32 v103, v71
    v_exp_f32 v104, v72
    v_mfma_f32_32x32x16_bf16 v[80:95], v[220:223], v[188:191], v[80:95]
    v_exp_f32 v105, v73
    v_exp_f32 v106, v74
    v_exp_f32 v107, v75
    v_mfma_f32_32x32x16_bf16 v[80:95], v[224:227], v[204:207], v[80:95]
    v_exp_f32 v108, v76
    v_exp_f32 v109, v77
    v_exp_f32 v110, v78
    v_exp_f32 v111, v79
    s_waitcnt vmcnt(0)
    ds_read_b128 v[208:211], v238
    ds_read_b128 v[212:215], v239
    ds_read_b128 v[216:219], v240
    ds_read_b128 v[220:223], v241
    v_add_u32_sdwa v249, s74, v242 dst_sel:DWORD dst_unused:UNUSED_PAD src0_sel:WORD_0 src1_sel:DWORD
    ds_read_b128 v[224:227], v249
    s_bitcmp1_b32 s75, 5
    s_cbranch_scc0 NQR_b7
    s_and_b32 s81, s75, 0xfe00fe00
    v_add_u32_sdwa v250, s81, v244 dst_sel:DWORD dst_unused:UNUSED_PAD src0_sel:WORD_0 src1_sel:DWORD
    v_add_u32_sdwa v40, s81, v244 dst_sel:DWORD dst_unused:UNUSED_PAD src0_sel:WORD_1 src1_sel:DWORD
    ds_read2_b32 v[44:45], v250 offset0:0 offset1:32
    ds_read2_b32 v[48:49], v40 offset0:0 offset1:32
    ds_read2_b32 v[46:47], v250 offset0:64 offset1:96
    ds_read2_b32 v[50:51], v40 offset0:64 offset1:96
NQR_b7:
    v_pk_fma_f32 v[228:229], v[116:117], v[96:97], v[116:117]
    v_pk_fma_f32 v[116:117], v[64:65], v[124:125], v[228:229]
    v_pk_fma_f32 v[124:125], v[124:125], v[96:97], v[124:125]
    v_pk_fma_f32 v[228:229], v[116:117], v[98:99], v[116:117]
    v_pk_fma_f32 v[116:117], v[66:67], v[124:125], v[228:229]
    v_pk_fma_f32 v[124:125], v[124:125], v[98:99], v[124:125]
    v_pk_fma_f32 v[228:229], v[116:117], v[100:101], v[116:117]
    v_pk_fma_f32 v[116:117], v[68:69], v[124:125], v[228:229]
    v_pk_fma_f32 v[124:125], v[124:125], v[100:101], v[124:125]
    v_pk_fma_f32 v[228:229], v[116:117], v[102:103], v[116:117]
    v_pk_fma_f32 v[116:117], v[70:71], v[124:125], v[228:229]
    v_pk_fma_f32 v[124:125], v[124:125], v[102:103], v[124:125]
    v_pk_fma_f32 v[228:229], v[116:117], v[104:105], v[116:117]
    v_pk_fma_f32 v[116:117], v[72:73], v[124:125], v[228:229]
    v_pk_fma_f32 v[124:125], v[124:125], v[104:105], v[124:125]
    v_pk_fma_f32 v[228:229], v[116:117], v[106:107], v[116:117]
    v_pk_fma_f32 v[116:117], v[74:75], v[124:125], v[228:229]
    v_pk_fma_f32 v[124:125], v[124:125], v[106:107], v[124:125]
    v_pk_fma_f32 v[228:229], v[116:117], v[108:109], v[116:117]
    v_pk_fma_f32 v[116:117], v[76:77], v[124:125], v[228:229]
    v_pk_fma_f32 v[124:125], v[124:125], v[108:109], v[124:125]
    v_rcp_f32 v36, v124
    v_rcp_f32 v37, v125
    v_pk_mul_f32 v[38:39], v[124:125], 0 op_sel_hi:[1,0]
    v_pk_fma_f32 v[38:39], v[116:117], v[36:37], v[38:39]
    v_pk_add_f32 v[124:125], v[110:111], 1.0 op_sel_hi:[1,0]
    v_add_f32 v34, v38, v39
    v_mov_b32 v116, v78
    v_mov_b32 v117, v79
    s_waitcnt lgkmcnt(0)
    s_bitcmp1_b32 s75, 5
    s_cbranch_scc0 NQM_b7
    v_perm_b32 v195, v48, v44, v41
    v_perm_b32 v199, v49, v45, v41
    v_perm_b32 v203, v50, v46, v41
    v_perm_b32 v207, v51, v47, v41
NQM_b7:
    v_mfma_f32_32x32x16_bf16 v[64:79], v[208:211], v[128:131], 0
    v_exp_f32 v96, v80
    v_exp_f32 v97, v81
    v_exp_f32 v98, v82
    v_mfma_f32_32x32x16_bf16 v[64:79], v[212:215], v[144:147], v[64:79]
    v_exp_f32 v99, v83
    v_exp_f32 v100, v84
    v_exp_f32 v101, v85
    v_mfma_f32_32x32x16_bf16 v[64:79], v[216:219], v[160:163], v[64:79]
    v_exp_f32 v102, v86
    v_exp_f32 v103, v87
    v_exp_f32 v104, v88
    v_mfma_f32_32x32x16_bf16 v[64:79], v[220:223], v[176:179], v[64:79]
    v_exp_f32 v105, v89
    v_exp_f32 v106, v90
    v_exp_f32 v107, v91
    v_mfma_f32_32x32x16_bf16 v[64:79], v[224:227], v[192:195], v[64:79]
    v_exp_f32 v108, v92
    v_exp_f32 v109, v93
    v_exp_f32 v110, v94
    v_exp_f32 v111, v95
    buffer_load_dwordx4 v[230:231], s[12:15], 0 idxen offen offset:0 lds
    buffer_load_dwordx4 v[232:233], s[12:15], 0 idxen offen offset:1024 lds
    buffer_load_dwordx4 v[234:235], s[12:15], 0 idxen offen offset:2048 lds
    buffer_load_dwordx4 v[236:237], s[12:15], 0 idxen offen offset:3072 lds
    v_add_u32_sdwa v251, s72, v246 dst_sel:DWORD dst_unused:UNUSED_PAD src0_sel:WORD_1 src1_sel:DWORD
    ds_read2st64_b32 v[252:253], v251 offset0:0 offset1:1
    v_pk_fma_f32 v[228:229], v[118:119], v[96:97], v[118:119]
    v_pk_fma_f32 v[118:119], v[80:81], v[126:127], v[228:229]
    v_pk_fma_f32 v[126:127], v[126:127], v[96:97], v[126:127]
    v_pk_fma_f32 v[228:229], v[118:119], v[98:99], v[118:119]
    v_pk_fma_f32 v[118:119], v[82:83], v[126:127], v[228:229]
    v_pk_fma_f32 v[126:127], v[126:127], v[98:99], v[126:127]
    v_pk_fma_f32 v[228:229], v[118:119], v[100:101], v[118:119]
    v_pk_fma_f32 v[118:119], v[84:85], v[126:127], v[228:229]
    v_pk_fma_f32 v[126:127], v[126:127], v[100:101], v[126:127]
    v_pk_fma_f32 v[228:229], v[118:119], v[102:103], v[118:119]
    v_pk_fma_f32 v[118:119], v[86:87], v[126:127], v[228:229]
    v_pk_fma_f32 v[126:127], v[126:127], v[102:103], v[126:127]
    v_pk_fma_f32 v[228:229], v[118:119], v[104:105], v[118:119]
    v_pk_fma_f32 v[118:119], v[88:89], v[126:127], v[228:229]
    v_pk_fma_f32 v[126:127], v[126:127], v[104:105], v[126:127]
    v_pk_fma_f32 v[228:229], v[118:119], v[106:107], v[118:119]
    v_pk_fma_f32 v[118:119], v[90:91], v[126:127], v[228:229]
    v_pk_fma_f32 v[126:127], v[126:127], v[106:107], v[126:127]
    v_pk_fma_f32 v[228:229], v[118:119], v[108:109], v[118:119]
    v_pk_fma_f32 v[118:119], v[92:93], v[126:127], v[228:229]
    v_pk_fma_f32 v[126:127], v[126:127], v[108:109], v[126:127]
    v_rcp_f32 v36, v126
    v_rcp_f32 v37, v127
    v_pk_mul_f32 v[38:39], v[126:127], 0 op_sel_hi:[1,0]
    v_pk_fma_f32 v[38:39], v[118:119], v[36:37], v[38:39]
    v_pk_add_f32 v[126:127], v[110:111], 1.0 op_sel_hi:[1,0]
    v_add_f32 v35, v38, v39
    v_mov_b32 v118, v94
    v_mov_b32 v119, v95
    s_nop 1
    v_permlane32_swap_b32 v32, v33
    v_permlane32_swap_b32 v34, v35
    v_add_f32 v32, v32, v33
    v_add_f32 v34, v34, v35
    s_waitcnt lgkmcnt(0)
    v_add_f32 v32, v32, v252
    v_add_f32 v34, v34, v253
    ds_write2st64_b32 v251, v32, v34 offset0:0 offset1:1
    s_cmp_lt_u32 s101, s95
    s_cbranch_scc1 NP_b7
    s_setprio 0
NP_b7:
    s_bitcmp1_b32 s73, 4
    s_cbranch_scc1 FLUSHB
    s_mov_b64 s[72:73], s[74:75]
    s_mov_b64 s[74:75], s[76:77]
    v_readlane_b32 s76, v247, s101
    v_readlane_b32 s77, v245, s101
    s_add_u32 s101, s101, 1
    s_and_b32 s84, s73, 15
    s_mul_i32 s85, s84, s3
    s_add_u32 s90, s10, s85
    s_addc_u32 s91, s11, 0
    s_setpc_b64 s[90:91]
GOSLOW:
    s_or_b32 s39, s39, 1
    s_waitcnt vmcnt(0) lgkmcnt(0)
    s_barrier
    s_branch RESTART0
MAINDONE:
    s_setprio 0
    s_waitcnt vmcnt(0) lgkmcnt(0)
    s_bitcmp1_b32 s39, 0
    s_cbranch_scc1 NOEARLY
    s_cmp_ge_u32 s36, 4
    s_cbranch_scc1 EL_END
    s_and_b32 s88, s36, 1
    v_lshlrev_b32 v6, 4, v1
    s_lshl_b32 s82, s88, 13
    s_add_u32 s82, s82, 9474048
    buffer_load_dwordx4 v[128:131], v6, s[20:23], s82 offen
    s_add_u32 s82, s82, 1024
    buffer_load_dwordx4 v[132:135], v6, s[20:23], s82 offen
    s_add_u32 s82, s82, 1024
    buffer_load_dwordx4 v[136:139], v6, s[20:23], s82 offen
    s_add_u32 s82, s82, 1024
    buffer_load_dwordx4 v[140:143], v6, s[20:23], s82 offen
    s_add_u32 s82, s82, 1024
    buffer_load_dwordx4 v[144:147], v6, s[20:23], s82 offen
    s_add_u32 s82, s82, 1024
    buffer_load_dwordx4 v[148:151], v6, s[20:23], s82 offen
    s_add_u32 s82, s82, 1024
    buffer_load_dwordx4 v[152:155], v6, s[20:23], s82 offen
    s_add_u32 s82, s82, 1024
    buffer_load_dwordx4 v[156:159], v6, s[20:23], s82 offen
    s_lshl_b32 s82, s88, 7
    s_add_u32 s82, s82, 9507328
    v_lshlrev_b32 v7, 4, v2
    buffer_load_dwordx4 v[192:195], v7, s[20:23], s82 offen offset:0
    buffer_load_dwordx4 v[196:199], v7, s[20:23], s82 offen offset:32
    buffer_load_dwordx4 v[200:203], v7, s[20:23], s82 offen offset:64
    buffer_load_dwordx4 v[204:207], v7, s[20:23], s82 offen offset:96
EL_END:
NOEARLY:
    s_barrier
    v_lshlrev_b32 v4, 2, v1
    v_add_u32 v5, 163088, v4
    ds_read_b32 v6, v5
    s_waitcnt lgkmcnt(0)
    v_readlane_b32 s80, v6, s36
    s_cmp_eq_u32 s80, -1
    s_cbranch_scc1 MERGED
    v_cmp_eq_u32 vcc, s80, v6
    s_nop 1
    s_and_b32 s84, vcc_lo, 0xff
    s_ff1_i32_b32 s81, s84
    s_cmp_eq_u32 s81, s36
    s_cbranch_scc0 MERGED
    s_mul_i32 s83, s80, 528
    v_add_u32 v7, 137216, v4
    v_add_u32 v8, s83, v7
    ds_read_b32 v10, v8
    ds_read_b32 v11, v8 offset:256
    v_mov_b32 v14, 0
MERGE_L:
    s_ff1_i32_b32 s81, s84
    s_bitset0_b32 s84, s81
    s_add_u32 s83, s81, 40
    s_mul_i32 s83, s83, 528
    v_add_u32 v9, s83, v7
    ds_read_b32 v12, v9
    ds_read_b32 v13, v9 offset:256
    s_waitcnt lgkmcnt(0)
    ds_write_b32 v9, v14
    ds_write_b32 v9, v14 offset:256
    v_add_f32 v10, v10, v12
    v_add_f32 v11, v11, v13
    s_cmp_lg_u32 s84, 0
    s_cbranch_scc1 MERGE_L
MERGE_W:
    ds_write_b32 v8, v10
    ds_write_b32 v8, v11 offset:256
MERGED:
    s_bitcmp1_b32 s39, 0
    s_cbranch_scc0 EPI
    s_waitcnt lgkmcnt(0)
SLOWADV:
    s_add_u32 s96, s96, 1
    s_cmp_lt_u32 s96, 250
    s_cbranch_scc1 SLOWNEXT
    s_waitcnt vmcnt(0)
    s_cmp_ge_u32 s36, 4
    s_cbranch_scc1 EL_ENDs
    s_and_b32 s88, s36, 1
    v_lshlrev_b32 v6, 4, v1
    s_lshl_b32 s82, s88, 13
    s_add_u32 s82, s82, 9474048
    buffer_load_dwordx4 v[128:131], v6, s[20:23], s82 offen
    s_add_u32 s82, s82, 1024
    buffer_load_dwordx4 v[132:135], v6, s[20:23], s82 offen
    s_add_u32 s82, s82, 1024
    buffer_load_dwordx4 v[136:139], v6, s[20:23], s82 offen
    s_add_u32 s82, s82, 1024
    buffer_load_dwordx4 v[140:143], v6, s[20:23], s82 offen
    s_add_u32 s82, s82, 1024
    buffer_load_dwordx4 v[144:147], v6, s[20:23], s82 offen
    s_add_u32 s82, s82, 1024
    buffer_load_dwordx4 v[148:151], v6, s[20:23], s82 offen
    s_add_u32 s82, s82, 1024
    buffer_load_dwordx4 v[152:155], v6, s[20:23], s82 offen
    s_add_u32 s82, s82, 1024
    buffer_load_dwordx4 v[156:159], v6, s[20:23], s82 offen
    s_lshl_b32 s82, s88, 7
    s_add_u32 s82, s82, 9507328
    v_lshlrev_b32 v7, 4, v2
    buffer_load_dwordx4 v[192:195], v7, s[20:23], s82 offen offset:0
    buffer_load_dwordx4 v[196:199], v7, s[20:23], s82 offen offset:32
    buffer_load_dwordx4 v[200:203], v7, s[20:23], s82 offen offset:64
    buffer_load_dwordx4 v[204:207], v7, s[20:23], s82 offen offset:96
EL_ENDs:
EPI:
EPI_BAR:
    s_waitcnt lgkmcnt(0)
    s_barrier
    s_cmp_ge_u32 s36, 4
    s_cbranch_scc1 EPI_FIN
    s_and_b32 s80, s36, 1
    s_lshr_b32 s81, s36, 1
    s_lshl_b32 s83, s81, 5
    v_add_u32 v8, s83, v3
    s_movk_i32 s84, 528
    v_mul_u32_u24 v9, s84, v8
    v_lshl_add_u32 v9, v2, 5, v9
    v_add_u32 v9, 137216, v9
    v_lshlrev_b32 v10, 2, v8
    v_add_u32 v10, 162816, v10
    ds_read_b32 v11, v10
    ds_read_b128 v[64:67], v9 offset:0
    ds_read_b128 v[68:71], v9 offset:16
    ds_read_b128 v[72:75], v9 offset:64
    ds_read_b128 v[76:79], v9 offset:80
    ds_read_b128 v[80:83], v9 offset:128
    ds_read_b128 v[84:87], v9 offset:144
    ds_read_b128 v[88:91], v9 offset:192
    ds_read_b128 v[92:95], v9 offset:208
    ds_read_b128 v[96:99], v9 offset:256
    ds_read_b128 v[100:103], v9 offset:272
    ds_read_b128 v[104:107], v9 offset:320
    ds_read_b128 v[108:111], v9 offset:336
    ds_read_b128 v[112:115], v9 offset:384
    ds_read_b128 v[116:119], v9 offset:400
    ds_read_b128 v[120:123], v9 offset:448
    ds_read_b128 v[124:127], v9 offset:464
    v_cmp_gt_u32 vcc, s38, v8
    v_add_u32 v8, s37, v8
    v_lshlrev_b32 v8, 7, v8
    v_lshl_add_u32 v8, v2, 3, v8
    s_lshl_b32 s83, s80, 6
    v_add_u32 v8, s83, v8
    s_mov_b64 s[82:83], vcc
    s_waitcnt vmcnt(0)
    s_waitcnt lgkmcnt(14)
    v_cvt_pk_bf16_f32 v12, v64, v65
    v_cvt_pk_bf16_f32 v13, v66, v67
    v_cvt_pk_bf16_f32 v14, v68, v69
    v_cvt_pk_bf16_f32 v15, v70, v71
    v_lshlrev_b32 v16, 16, v12
    v_and_b32 v17, 0xffff0000, v12
    v_lshlrev_b32 v18, 16, v13
    v_and_b32 v19, 0xffff0000, v13
    v_lshlrev_b32 v20, 16, v14
    v_and_b32 v21, 0xffff0000, v14
    v_lshlrev_b32 v22, 16, v15
    v_and_b32 v23, 0xffff0000, v15
    v_pk_add_f32 v[64:65], v[64:65], v[16:17] neg_lo:[0,1] neg_hi:[0,1]
    v_pk_add_f32 v[66:67], v[66:67], v[18:19] neg_lo:[0,1] neg_hi:[0,1]
    v_pk_add_f32 v[68:69], v[68:69], v[20:21] neg_lo:[0,1] neg_hi:[0,1]
    v_pk_add_f32 v[70:71], v[70:71], v[22:23] neg_lo:[0,1] neg_hi:[0,1]
    v_cvt_pk_bf16_f32 v24, v64, v65
    v_cvt_pk_bf16_f32 v25, v66, v67
    v_cvt_pk_bf16_f32 v26, v68, v69
    v_cvt_pk_bf16_f32 v27, v70, v71
    s_nop 1
    v_mfma_f32_32x32x16_bf16 v[208:223], v[128:131], v[12:15], 0
    v_mfma_f32_32x32x16_bf16 v[208:223], v[128:131], v[24:27], v[208:223]
    s_waitcnt lgkmcnt(12)
    v_cvt_pk_bf16_f32 v28, v72, v73
    v_cvt_pk_bf16_f32 v29, v74, v75
    v_cvt_pk_bf16_f32 v30, v76, v77
    v_cvt_pk_bf16_f32 v31, v78, v79
    v_lshlrev_b32 v32, 16, v28
    v_and_b32 v33, 0xffff0000, v28
    v_lshlrev_b32 v34, 16, v29
    v_and_b32 v35, 0xffff0000, v29
    v_lshlrev_b32 v36, 16, v30
    v_and_b32 v37, 0xffff0000, v30
    v_lshlrev_b32 v38, 16, v31
    v_and_b32 v39, 0xffff0000, v31
    v_pk_add_f32 v[72:73], v[72:73], v[32:33] neg_lo:[0,1] neg_hi:[0,1]
    v_pk_add_f32 v[74:75], v[74:75], v[34:35] neg_lo:[0,1] neg_hi:[0,1]
    v_pk_add_f32 v[76:77], v[76:77], v[36:37] neg_lo:[0,1] neg_hi:[0,1]
    v_pk_add_f32 v[78:79], v[78:79], v[38:39] neg_lo:[0,1] neg_hi:[0,1]
    v_cvt_pk_bf16_f32 v40, v72, v73
    v_cvt_pk_bf16_f32 v41, v74, v75
    v_cvt_pk_bf16_f32 v42, v76, v77
    v_cvt_pk_bf16_f32 v43, v78, v79
    s_nop 1
    v_mfma_f32_32x32x16_bf16 v[208:223], v[132:135], v[28:31], v[208:223]
    v_mfma_f32_32x32x16_bf16 v[208:223], v[132:135], v[40:43], v[208:223]
    s_waitcnt lgkmcnt(10)
    v_cvt_pk_bf16_f32 v12, v80, v81
    v_cvt_pk_bf16_f32 v13, v82, v83
    v_cvt_pk_bf16_f32 v14, v84, v85
    v_cvt_pk_bf16_f32 v15, v86, v87
    v_lshlrev_b32 v16, 16, v12
    v_and_b32 v17, 0xffff0000, v12
    v_lshlrev_b32 v18, 16, v13
    v_and_b32 v19, 0xffff0000, v13
    v_lshlrev_b32 v20, 16, v14
    v_and_b32 v21, 0xffff0000, v14
    v_lshlrev_b32 v22, 16, v15
    v_and_b32 v23, 0xffff0000, v15
    v_pk_add_f32 v[80:81], v[80:81], v[16:17] neg_lo:[0,1] neg_hi:[0,1]
    v_pk_add_f32 v[82:83], v[82:83], v[18:19] neg_lo:[0,1] neg_hi:[0,1]
    v_pk_add_f32 v[84:85], v[84:85], v[20:21] neg_lo:[0,1] neg_hi:[0,1]
    v_pk_add_f32 v[86:87], v[86:87], v[22:23] neg_lo:[0,1] neg_hi:[0,1]
    v_cvt_pk_bf16_f32 v24, v80, v81
    v_cvt_pk_bf16_f32 v25, v82, v83
    v_cvt_pk_bf16_f32 v26, v84, v85
    v_cvt_pk_bf16_f32 v27, v86, v87
    s_nop 1
    v_mfma_f32_32x32x16_bf16 v[208:223], v[136:139], v[12:15], v[208:223]
    v_mfma_f32_32x32x16_bf16 v[208:223], v[136:139], v[24:27], v[208:223]
    s_waitcnt lgkmcnt(8)
    v_cvt_pk_bf16_f32 v28, v88, v89
    v_cvt_pk_bf16_f32 v29, v90, v91
    v_cvt_pk_bf16_f32 v30, v92, v93
    v_cvt_pk_bf16_f32 v31, v94, v95
    v_lshlrev_b32 v32, 16, v28
    v_and_b32 v33, 0xffff0000, v28
    v_lshlrev_b32 v34, 16, v29
    v_and_b32 v35, 0xffff0000, v29
    v_lshlrev_b32 v36, 16, v30
    v_and_b32 v37, 0xffff0000, v30
    v_lshlrev_b32 v38, 16, v31
    v_and_b32 v39, 0xffff0000, v31
    v_pk_add_f32 v[88:89], v[88:89], v[32:33] neg_lo:[0,1] neg_hi:[0,1]
    v_pk_add_f32 v[90:91], v[90:91], v[34:35] neg_lo:[0,1] neg_hi:[0,1]
    v_pk_add_f32 v[92:93], v[92:93], v[36:37] neg_lo:[0,1] neg_hi:[0,1]
    v_pk_add_f32 v[94:95], v[94:95], v[38:39] neg_lo:[0,1] neg_hi:[0,1]
    v_cvt_pk_bf16_f32 v40, v88, v89
    v_cvt_pk_bf16_f32 v41, v90, v91
    v_cvt_pk_bf16_f32 v42, v92, v93
    v_cvt_pk_bf16_f32 v43, v94, v95
    s_nop 1
    v_mfma_f32_32x32x16_bf16 v[208:223], v[140:143], v[28:31], v[208:223]
    v_mfma_f32_32x32x16_bf16 v[208:223], v[140:143], v[40:43], v[208:223]
    s_waitcnt lgkmcnt(6)
    v_cvt_pk_bf16_f32 v12, v96, v97
    v_cvt_pk_bf16_f32 v13, v98, v99
    v_cvt_pk_bf16_f32 v14, v100, v101
    v_cvt_pk_bf16_f32 v15, v102, v103
    v_lshlrev_b32 v16, 16, v12
    v_and_b32 v17, 0xffff0000, v12
    v_lshlrev_b32 v18, 16, v13
    v_and_b32 v19, 0xffff0000, v13
    v_lshlrev_b32 v20, 16, v14
    v_and_b32 v21, 0xffff0000, v14
    v_lshlrev_b32 v22, 16, v15
    v_and_b32 v23, 0xffff0000, v15
    v_pk_add_f32 v[96:97], v[96:97], v[16:17] neg_lo:[0,1] neg_hi:[0,1]
    v_pk_add_f32 v[98:99], v[98:99], v[18:19] neg_lo:[0,1] neg_hi:[0,1]
    v_pk_add_f32 v[100:101], v[100:101], v[20:21] neg_lo:[0,1] neg_hi:[0,1]
    v_pk_add_f32 v[102:103], v[102:103], v[22:23] neg_lo:[0,1] neg_hi:[0,1]
    v_cvt_pk_bf16_f32 v24, v96, v97
    v_cvt_pk_bf16_f32 v25, v98, v99
    v_cvt_pk_bf16_f32 v26, v100, v101
    v_cvt_pk_bf16_f32 v27, v102, v103
    s_nop 1
    v_mfma_f32_32x32x16_bf16 v[208:223], v[144:147], v[12:15], v[208:223]
    v_mfma_f32_32x32x16_bf16 v[208:223], v[144:147], v[24:27], v[208:223]
    s_waitcnt lgkmcnt(4)
    v_cvt_pk_bf16_f32 v28, v104, v105
    v_cvt_pk_bf16_f32 v29, v106, v107
    v_cvt_pk_bf16_f32 v30, v108, v109
    v_cvt_pk_bf16_f32 v31, v110, v111
    v_lshlrev_b32 v32, 16, v28
    v_and_b32 v33, 0xffff0000, v28
    v_lshlrev_b32 v34, 16, v29
    v_and_b32 v35, 0xffff0000, v29
    v_lshlrev_b32 v36, 16, v30
    v_and_b32 v37, 0xffff0000, v30
    v_lshlrev_b32 v38, 16, v31
    v_and_b32 v39, 0xffff0000, v31
    v_pk_add_f32 v[104:105], v[104:105], v[32:33] neg_lo:[0,1] neg_hi:[0,1]
    v_pk_add_f32 v[106:107], v[106:107], v[34:35] neg_lo:[0,1] neg_hi:[0,1]
    v_pk_add_f32 v[108:109], v[108:109], v[36:37] neg_lo:[0,1] neg_hi:[0,1]
    v_pk_add_f32 v[110:111], v[110:111], v[38:39] neg_lo:[0,1] neg_hi:[0,1]
    v_cvt_pk_bf16_f32 v40, v104, v105
    v_cvt_pk_bf16_f32 v41, v106, v107
    v_cvt_pk_bf16_f32 v42, v108, v109
    v_cvt_pk_bf16_f32 v43, v110, v111
    s_nop 1
    v_mfma_f32_32x32x16_bf16 v[208:223], v[148:151], v[28:31], v[208:223]
    v_mfma_f32_32x32x16_bf16 v[208:223], v[148:151], v[40:43], v[208:223]
    s_waitcnt lgkmcnt(2)
    v_cvt_pk_bf16_f32 v12, v112, v113
    v_cvt_pk_bf16_f32 v13, v114, v115
    v_cvt_pk_bf16_f32 v14, v116, v117
    v_cvt_pk_bf16_f32 v15, v118, v119
    v_lshlrev_b32 v16, 16, v12
    v_and_b32 v17, 0xffff0000, v12
    v_lshlrev_b32 v18, 16, v13
    v_and_b32 v19, 0xffff0000, v13
    v_lshlrev_b32 v20, 16, v14
    v_and_b32 v21, 0xffff0000, v14
    v_lshlrev_b32 v22, 16, v15
    v_and_b32 v23, 0xffff0000, v15
    v_pk_add_f32 v[112:113], v[112:113], v[16:17] neg_lo:[0,1] neg_hi:[0,1]
    v_pk_add_f32 v[114:115], v[114:115], v[18:19] neg_lo:[0,1] neg_hi:[0,1]
    v_pk_add_f32 v[116:117], v[116:117], v[20:21] neg_lo:[0,1] neg_hi:[0,1]
    v_pk_add_f32 v[118:119], v[118:119], v[22:23] neg_lo:[0,1] neg_hi:[0,1]
    v_cvt_pk_bf16_f32 v24, v112, v113
    v_cvt_pk_bf16_f32 v25, v114, v115
    v_cvt_pk_bf16_f32 v26, v116, v117
    v_cvt_pk_bf16_f32 v27, v118, v119
    s_nop 1
    v_mfma_f32_32x32x16_bf16 v[208:223], v[152:155], v[12:15], v[208:223]
    v_mfma_f32_32x32x16_bf16 v[208:223], v[152:155], v[24:27], v[208:223]
    s_waitcnt lgkmcnt(0)
    v_cvt_pk_bf16_f32 v28, v120, v121
    v_cvt_pk_bf16_f32 v29, v122, v123
    v_cvt_pk_bf16_f32 v30, v124, v125
    v_cvt_pk_bf16_f32 v31, v126, v127
    v_lshlrev_b32 v32, 16, v28
    v_and_b32 v33, 0xffff0000, v28
    v_lshlrev_b32 v34, 16, v29
    v_and_b32 v35, 0xffff0000, v29
    v_lshlrev_b32 v36, 16, v30
    v_and_b32 v37, 0xffff0000, v30
    v_lshlrev_b32 v38, 16, v31
    v_and_b32 v39, 0xffff0000, v31
    v_pk_add_f32 v[120:121], v[120:121], v[32:33] neg_lo:[0,1] neg_hi:[0,1]
    v_pk_add_f32 v[122:123], v[122:123], v[34:35] neg_lo:[0,1] neg_hi:[0,1]
    v_pk_add_f32 v[124:125], v[124:125], v[36:37] neg_lo:[0,1] neg_hi:[0,1]
    v_pk_add_f32 v[126:127], v[126:127], v[38:39] neg_lo:[0,1] neg_hi:[0,1]
    v_cvt_pk_bf16_f32 v40, v120, v121
    v_cvt_pk_bf16_f32 v41, v122, v123
    v_cvt_pk_bf16_f32 v42, v124, v125
    v_cvt_pk_bf16_f32 v43, v126, v127
    s_nop 1
    v_mfma_f32_32x32x16_bf16 v[208:223], v[156:159], v[28:31], v[208:223]
    v_mfma_f32_32x32x16_bf16 v[208:223], v[156:159], v[40:43], v[208:223]
    v_cvt_f32_u32 v11, v11
    s_mov_b32 s85, 0xbf317218
    v_mul_f32 v192, v11, v192
    v_mul_f32 v193, v11, v193
    v_mul_f32 v194, v11, v194
    v_mul_f32 v195, v11, v195
    v_mul_f32 v196, v11, v196
    v_mul_f32 v197, v11, v197
    v_mul_f32 v198, v11, v198
    v_mul_f32 v199, v11, v199
    v_mul_f32 v200, v11, v200
    v_mul_f32 v201, v11, v201
    v_mul_f32 v202, v11, v202
    v_mul_f32 v203, v11, v203
    v_mul_f32 v204, v11, v204
    v_mul_f32 v205, v11, v205
    v_mul_f32 v206, v11, v206
    v_mul_f32 v207, v11, v207
    v_fma_f32 v208, v208, s85, v192
    v_fma_f32 v209, v209, s85, v193
    v_fma_f32 v210, v210, s85, v194
    v_fma_f32 v211, v211, s85, v195
    v_fma_f32 v212, v212, s85, v196
    v_fma_f32 v213, v213, s85, v197
    v_fma_f32 v214, v214, s85, v198
    v_fma_f32 v215, v215, s85, v199
    v_fma_f32 v216, v216, s85, v200
    v_fma_f32 v217, v217, s85, v201
    v_fma_f32 v218, v218, s85, v202
    v_fma_f32 v219, v219, s85, v203
    v_fma_f32 v220, v220, s85, v204
    v_fma_f32 v221, v221, s85, v205
    v_fma_f32 v222, v222, s85, v206
    v_fma_f32 v223, v223, s85, v207
    v_mov_b32 v12, 0
    v_mov_b32 v13, 0
    v_pk_fma_f32 v[12:13], v[208:209], 0, v[12:13] op_sel_hi:[1,0,1]
    v_pk_fma_f32 v[12:13], v[210:211], 0, v[12:13] op_sel_hi:[1,0,1]
    v_pk_fma_f32 v[12:13], v[212:213], 0, v[12:13] op_sel_hi:[1,0,1]
    v_pk_fma_f32 v[12:13], v[214:215], 0, v[12:13] op_sel_hi:[1,0,1]
    v_pk_fma_f32 v[12:13], v[216:217], 0, v[12:13] op_sel_hi:[1,0,1]
    v_pk_fma_f32 v[12:13], v[218:219], 0, v[12:13] op_sel_hi:[1,0,1]
    v_pk_fma_f32 v[12:13], v[220:221], 0, v[12:13] op_sel_hi:[1,0,1]
    v_pk_fma_f32 v[12:13], v[222:223], 0, v[12:13] op_sel_hi:[1,0,1]
    v_add_f32 v12, v12, v13
    v_cvt_pk_bf16_f32 v16, v208, v209
    v_cvt_pk_bf16_f32 v17, v210, v211
    v_cvt_pk_bf16_f32 v18, v212, v213
    v_cvt_pk_bf16_f32 v19, v214, v215
    v_cvt_pk_bf16_f32 v20, v216, v217
    v_cvt_pk_bf16_f32 v21, v218, v219
    v_cvt_pk_bf16_f32 v22, v220, v221
    v_cvt_pk_bf16_f32 v23, v222, v223
    v_cmp_u_f32 vcc, v12, v12
    s_mov_b64 exec, s[82:83]
    buffer_store_dwordx2 v[16:17], v8, s[32:35], 0 offen offset:0
    buffer_store_dwordx2 v[18:19], v8, s[32:35], 0 offen offset:16
    buffer_store_dwordx2 v[20:21], v8, s[32:35], 0 offen offset:32
    buffer_store_dwordx2 v[22:23], v8, s[32:35], 0 offen offset:48
    s_mov_b64 exec, -1
    s_and_b64 vcc, vcc, s[82:83]
    s_cmp_eq_u64 vcc, 0
    s_cbranch_scc1 EPI_FIN
    v_mov_b32 v10, 163076
    v_mov_b32 v11, 1
    ds_write_b32 v10, v11
EPI_FIN:
    s_bitcmp1_b32 s39, 1
    s_cbranch_scc1 K2_END
    s_waitcnt lgkmcnt(0)
    s_barrier
    v_mov_b32 v10, 163076
    ds_read_b32 v11, v10
    s_waitcnt lgkmcnt(0)
    v_readfirstlane_b32 s80, v11
    s_cmp_eq_u32 s80, 0
    s_cbranch_scc1 K2_END
    s_or_b32 s39, s39, 2
    s_waitcnt vmcnt(0)
    s_barrier
RESTART0:
    v_lshlrev_b32 v52, 2, v3
    v_and_b32 v242, 0x19, v3
    v_and_b32 v54, 2, v3
    v_and_b32 v55, 4, v3
    v_lshlrev_b32 v54, 1, v54
    v_lshrrev_b32 v55, 1, v55
    v_or3_b32 v242, v242, v54, v55
    v_lshlrev_b32 v242, 4, v242
    v_lshrrev_b32 v56, 3, v1
    v_and_b32 v243, 0x19, v56
    v_and_b32 v54, 2, v56
    v_and_b32 v55, 4, v56
    v_lshlrev_b32 v54, 1, v54
    v_lshrrev_b32 v55, 1, v55
    v_or3_b32 v243, v243, v54, v55
    v_lshl_add_u32 v243, v243, 4, 8
    v_and_b32 v57, 7, v1
    v_lshrrev_b32 v56, 1, v56
    v_xor_b32 v57, v57, v56
    v_lshlrev_b32 v57, 4, v57
    v_xor_b32 v56, 64, v57
    v_add_u32 v231, 3072, v57
    v_add_u32 v233, 2048, v56
    v_add_u32 v235, 1024, v57
    v_mov_b32 v237, v56
    v_bfe_u32 v54, v3, 1, 3
    v_xor_b32 v54, v54, v2
    v_lshlrev_b32 v54, 4, v54
    v_lshl_add_u32 v54, v3, 7, v54
    v_add_u32 v58, 87552, v54
    v_add_u32 v54, s100, v54
    v_xor_b32 v238, 0, v54
    v_xor_b32 v239, 32, v54
    v_xor_b32 v240, 64, v54
    v_xor_b32 v241, 96, v54
    v_add_u32 v244, 116224, v52
    v_lshlrev_b32 v246, 2, v1
    v_add_u32 v246, 137216, v246
    s_branch RESTART
K2_END:
    s_cmp_eq_u32 s26, 0
    s_cbranch_scc0 K2_EXIT
    s_cmp_eq_u32 s36, 0
    s_cbranch_scc0 K2_EXIT
    s_mov_b64 exec, 1
    v_mov_b32 v4, 9371648
    v_mov_b32 v5, s94
    buffer_store_dword v5, v4, s[20:23], 0 offen
K2_EXIT:
    s_endpgm
.section .rodata,"a"
.p2align 6
.amdhsa_kernel standalone__edge_featured_mpnn_mpnn__graph_kernel
  .amdhsa_next_free_vgpr 256
  .amdhsa_next_free_sgpr 102
  .amdhsa_accum_offset 256
  .amdhsa_group_segment_fixed_size 0
  .amdhsa_kernarg_size 88
  .amdhsa_user_sgpr_count 2
  .amdhsa_user_sgpr_kernarg_segment_ptr 1
  .amdhsa_system_sgpr_workgroup_id_x 1
  .amdhsa_float_denorm_mode_32 3
  .amdhsa_float_denorm_mode_16_64 3
.end_amdhsa_kernel
.text
```
